```python
import torch

def _softmax(x, axis=-1):
    return torch.softmax(x, dim=axis)
def _gelu(x):
    return torch.nn.functional.gelu(x, approximate="tanh")
def _silu(x):
    return torch.nn.functional.silu(x)
def _sigmoid(x):
    return torch.sigmoid(x)
def _layernorm(x, axis=-1, eps=1e-5):
    m = x.mean(dim=axis, keepdim=True)
    v = x.var(dim=axis, keepdim=True, unbiased=False)
    return (x - m) / torch.sqrt(v + eps)
def _scatter_add(tgt, idx, src, axis=0):
    return tgt.clone().index_add_(axis, idx, src)
def _segment_sum(src, seg, n):
    out = torch.zeros((n,) + src.shape[1:], dtype=src.dtype)
    return out.index_add_(0, seg, src)
def _pad(x, pw):
    flat = tuple(v for pair in reversed(pw) for v in pair)
    return torch.nn.functional.pad(x, flat)

kernel_name = 'gated_mix__linear_kernel_hedgehog__linear_kernel_hedgehog__prompt'

def setup_inputs():

    _w = (lambda a: (lambda t: t.to(torch.bfloat16) if t.is_floating_point() else t)(torch.as_tensor(a)))
    def _A_setup():
        B, S, D, H = 1, 2048, 448, 16
        Dh = D // H
        return {
            "x": _w((lambda *s: torch.randn(*s, dtype=torch.bfloat16) * 0.05)(B, S, D)),
            "wqkv": _w((lambda *s: torch.randn(*s, dtype=torch.bfloat16) * 0.8)(D, 3 * D)),
            "w_phi": _w((lambda *s: torch.randn(*s, dtype=torch.bfloat16) * 0.8)(H, Dh, Dh) * (Dh ** -0.5)),
            "wo": _w((lambda *s: torch.randn(*s, dtype=torch.bfloat16) * 0.05)(D, D)),
        }
    _A_in = _A_setup()

    def _B_setup():
        B, S, D, H = 1, 2048, 448, 16
        Dh = D // H
        return {
            "x": _w((lambda *s: torch.randn(*s, dtype=torch.bfloat16) * 0.05)(B, S, D)),
            "wqkv": _w((lambda *s: torch.randn(*s, dtype=torch.bfloat16) * 0.8)(D, 3 * D)),
            "w_phi": _w((lambda *s: torch.randn(*s, dtype=torch.bfloat16) * 0.8)(H, Dh, Dh) * (Dh ** -0.5)),
            "wo": _w((lambda *s: torch.randn(*s, dtype=torch.bfloat16) * 0.05)(D, D)),
        }
    _B_in = _B_setup()

    return {
        "A_x": _A_in["x"],
        "A_wqkv": _A_in["wqkv"],
        "A_w_phi": _A_in["w_phi"],
        "A_wo": _A_in["wo"],
        "B_x": _B_in["x"],
        "B_wqkv": _B_in["wqkv"],
        "B_w_phi": _B_in["w_phi"],
        "B_wo": _B_in["wo"],
        "gate_w": _w((lambda *s: torch.randn(*s, dtype=torch.bfloat16) * 0.05)(448) * 16.0),
    }

def reference(A_x, A_wqkv, A_w_phi, A_wo, B_x, B_wqkv, B_w_phi, B_wo, gate_w):
    def _A_ref(x, wqkv, w_phi, wo):
        B, S, D = x.shape
        H = 16; Dh = D // H
        qkv = (lambda x, *d: x.permute(*d))((x @ wqkv).reshape(B, S, 3, H, Dh), 2, 0, 3, 1, 4)
        q, k, v = qkv[0], qkv[1], qkv[2]
        pq = torch.einsum("bhsd,hdf->bhsf", q, w_phi)
        pk = torch.einsum("bhsd,hdf->bhsf", k, w_phi)
        phi_q = torch.concatenate([_softmax(pq, axis=-1), _softmax(-pq, axis=-1)], axis=-1)
        phi_k = torch.concatenate([_softmax(pk, axis=-1), _softmax(-pk, axis=-1)], axis=-1)
        kv = torch.einsum("bhsf,bhsd->bhfd", phi_k, v)
        z  = torch.einsum("bhsf->bhf", phi_k)
        num = torch.einsum("bhqf,bhfd->bhqd", phi_q, kv)
        den = torch.einsum("bhqf,bhf->bhq", phi_q, z)[..., None] + 1e-6
        o = num / den
        return (lambda x, *d: x.permute(*d))(o, 0, 2, 1, 3).reshape(B, S, D) @ wo

    def _B_ref(x, wqkv, w_phi, wo):
        B, S, D = x.shape
        H = 16; Dh = D // H
        qkv = (lambda x, *d: x.permute(*d))((x @ wqkv).reshape(B, S, 3, H, Dh), 2, 0, 3, 1, 4)
        q, k, v = qkv[0], qkv[1], qkv[2]
        pq = torch.einsum("bhsd,hdf->bhsf", q, w_phi)
        pk = torch.einsum("bhsd,hdf->bhsf", k, w_phi)
        phi_q = torch.concatenate([_softmax(pq, axis=-1), _softmax(-pq, axis=-1)], axis=-1)
        phi_k = torch.concatenate([_softmax(pk, axis=-1), _softmax(-pk, axis=-1)], axis=-1)
        kv = torch.einsum("bhsf,bhsd->bhfd", phi_k, v)
        z  = torch.einsum("bhsf->bhf", phi_k)
        num = torch.einsum("bhqf,bhfd->bhqd", phi_q, kv)
        den = torch.einsum("bhqf,bhf->bhq", phi_q, z)[..., None] + 1e-6
        o = num / den
        return (lambda x, *d: x.permute(*d))(o, 0, 2, 1, 3).reshape(B, S, D) @ wo

    x = A_x
    g = _sigmoid((x * gate_w).sum(-1, keepdims=True))
    a = _A_ref(x, A_wqkv, A_w_phi, A_wo)
    b = _B_ref(x, B_wqkv, B_w_phi, B_wo)
    return g * a + (1 - g) * b
```

```asm
; @launch grid=(256,1,1) block=(512,1,1) lds=163840
.amdgcn_target "amdgcn-amd-amdhsa--gfx950"
.text
.globl gated_mix__linear_kernel_hedgehog__linear_kernel_hedgehog__prompt_kernel
.p2align 8
.type gated_mix__linear_kernel_hedgehog__linear_kernel_hedgehog__prompt_kernel,@function
.set CODE_KB_LEFT, ((L_end - L_pc) / 1024) - 1
gated_mix__linear_kernel_hedgehog__linear_kernel_hedgehog__prompt_kernel:
    s_cmp_ge_u32 s2, 256
    s_cbranch_scc1 L_exit
    s_load_dwordx16 s[4:19], s[0:1], 0
    s_load_dwordx8 s[20:27], s[0:1], 64
    v_lshrrev_b32 v5, 6, v0
    v_and_b32 v1, 63, v0
    s_lshr_b32 s70, s2, 3
    v_readfirstlane_b32 s56, v5
    s_getpc_b64 s[76:77]
L_pc:
    s_and_b32 s65, s70, 1
    s_lshl_b32 s65, s65, 3
    s_add_u32 s65, s65, s56
    s_min_u32 s65, s65, CODE_KB_LEFT
    s_lshl_b32 s65, s65, 10
    v_lshlrev_b32 v6, 4, v1
    v_add_u32 v6, s65, v6
    global_load_dwordx4 v[88:91], v6, s[76:77]
    s_and_b32 s89, s2, 7
    s_and_b32 s65, s89, 1
    s_lshl_b32 s65, s65, 3
    s_and_b32 s61, s70, 7
    s_add_u32 s57, s65, s61
    s_lshr_b32 s58, s89, 2
    s_and_b32 s59, s89, 2
    s_lshl_b32 s59, s59, 1
    s_lshr_b32 s65, s70, 3
    s_add_u32 s59, s59, s65
    s_lshl_b32 s65, s65, 1
    s_add_u32 s61, s61, s65
    s_cmp_ge_u32 s61, 7
    s_cselect_b32 s65, 7, 0
    s_sub_u32 s61, s61, s65
    s_lshl_b32 s60, s58, 3
    s_add_u32 s60, s60, s59
    s_sub_u32 s62, 7, s61
    s_lshl_b32 s65, s57, 7
    s_lshl_b32 s66, s56, 4
    s_add_u32 s65, s65, s66
    s_mul_i32 s63, s65, 896
    s_lshl_b32 s65, s61, 7
    s_add_u32 s63, s63, s65
    s_mul_i32 s64, s56, 21504
    s_mul_i32 s65, s59, 112
    s_add_u32 s64, s64, s65
    s_mul_i32 s65, s61, 172032
    s_add_u32 s64, s64, s65
    s_add_u32 s64, s64, 896
    s_lshl_b32 s67, s56, 11
    s_lshl_b32 s68, s56, 10
    s_movk_i32 s94, 128
    s_mov_b32 s95, 172032
    v_lshrrev_b32 v5, 3, v1
    v_and_b32 v6, 7, v1
    v_lshrrev_b32 v7, 1, v5
    v_xor_b32 v8, v6, v7
    v_lshlrev_b32 v8, 4, v8
    v_mul_u32_u24 v9, 896, v5
    v_add_u32 v106, v9, v8
    v_xor_b32 v8, 64, v8
    v_add_u32 v107, v9, v8
    v_add_u32 v107, 7168, v107
    v_and_b32 v8, 1, v7
    v_lshlrev_b32 v8, 2, v8
    v_xor_b32 v8, v6, v8
    v_add_u32 v10, 1, v8
    v_lshrrev_b32 v10, 3, v10
    v_lshlrev_b32 v10, 30, v10
    v_lshlrev_b32 v8, 4, v8
    v_mul_u32_u24 v9, 2688, v5
    v_add3_u32 v108, v9, v8, v10
    s_waitcnt lgkmcnt(0)
    s_mov_b32 s28, s4
    s_mov_b32 s29, s5
    s_mov_b32 s30, 1835008
    s_mov_b32 s31, 0x00020000
    s_mov_b64 s[84:85], s[6:7]
    s_mov_b64 s[86:87], s[14:15]
    s_cmp_eq_u32 s58, 0
    s_cselect_b32 s32, s6, s14
    s_cselect_b32 s33, s7, s15
    s_mov_b32 s34, 1204224
    s_mov_b32 s35, 0x00020000
    s_add_u32 m0, s67, 0
    s_cmp_eq_u32 s62, 1
    buffer_load_dwordx4 v106, s[28:31], s63 offen lds
    s_cselect_b32 s76, 0xfffffd00, s94
    s_cselect_b32 s77, 0xfff04000, s95
    s_add_u32 m0, s67, 1024
    s_sub_u32 s4, s64, 896
    buffer_load_dwordx4 v107, s[28:31], s63 offen lds
    s_add_u32 s63, s63, s76
    s_add_u32 m0, s68, 16384
    s_add_u32 s65, s64, 896
    buffer_load_dwordx4 v108, s[32:35], s64 offen lds
    s_add_u32 m0, s68, 24576
    s_add_u32 s64, s64, s77
    buffer_load_dwordx4 v108, s[32:35], s65 offen lds
    s_barrier
    v_lshlrev_b32 v14, 4, v1
    v_and_b32 v5, 31, v1
    v_lshrrev_b32 v6, 5, v1
    v_lshrrev_b32 v7, 1, v5
    v_and_b32 v7, 7, v7
    v_xor_b32 v7, v7, v6
    v_lshlrev_b32 v7, 4, v7
    s_and_b32 s90, s56, 3
    s_lshl_b32 s90, s90, 12
    v_lshlrev_b32 v8, 7, v5
    v_add_u32 v8, s90, v8
    v_add_u32 v8, v8, v7
    v_xor_b32 v96, 0, v8
    v_add_u32 v100, 65536, v96
    v_xor_b32 v97, 32, v8
    v_add_u32 v101, 65536, v97
    v_xor_b32 v98, 64, v8
    v_add_u32 v102, 65536, v98
    v_xor_b32 v99, 96, v8
    v_add_u32 v103, 65536, v99
    v_and_b32 v7, 15, v1
    v_lshrrev_b32 v8, 2, v7
    v_and_b32 v7, 3, v7
    v_lshlrev_b32 v7, 3, v7
    v_and_b32 v9, 16, v1
    v_lshlrev_b32 v9, 1, v9
    v_add_u32 v7, v7, v9
    s_lshr_b32 s90, s56, 2
    s_mul_i32 s91, s90, 56
    s_add_u32 m0, s67, 32768
    s_cmp_eq_u32 s62, 2
    buffer_load_dwordx4 v106, s[28:31], s63 offen lds
    s_cselect_b32 s76, 0xfffffd00, s94
    s_cselect_b32 s77, 0xfff04000, s95
    v_add_u32 v7, s91, v7
    v_and_b32 v9, 2, v8
    v_lshlrev_b32 v9, 5, v9
    v_xor_b32 v7, v7, v9
    v_lshlrev_b32 v9, 3, v6
    v_add_u32 v9, v9, v8
    v_lshlrev_b32 v9, 7, v9
    v_add_u32 v104, v9, v7
    v_add_u32 v105, 65536, v104
    v_add_u32 v142, 98304, v104
    s_lshl_b32 s91, s61, 7
    s_add_u32 s91, s91, 159744
    v_lshlrev_b32 v141, 4, v6
    v_add_u32 v141, s91, v141
    v_and_b32 v7, 5, v5
    v_and_b32 v8, 2, v5
    v_lshlrev_b32 v8, 2, v8
    v_or_b32 v7, v7, v8
    v_and_b32 v8, 8, v5
    v_lshrrev_b32 v8, 2, v8
    v_or_b32 v7, v7, v8
    v_xor_b32 v7, v7, v6
    v_lshlrev_b32 v7, 3, v7
    v_lshlrev_b32 v8, 7, v5
    v_add_u32 v7, v7, v8
    s_and_b32 s91, s56, 3
    s_lshl_b32 s91, s91, 12
    s_lshl_b32 s90, s90, 14
    s_add_u32 m0, s67, 33792
    s_sub_u32 s5, s64, 896
    buffer_load_dwordx4 v107, s[28:31], s63 offen lds
    s_add_u32 s63, s63, s76
    s_add_u32 s91, s91, s90
    s_add_u32 s91, s91, 0
    v_add_u32 v143, s91, v7
    v_xor_b32 v124, 0, v143
    v_xor_b32 v125, 16, v143
    v_xor_b32 v126, 32, v143
    v_xor_b32 v127, 48, v143
    v_xor_b32 v136, 64, v143
    v_xor_b32 v137, 80, v143
    v_xor_b32 v138, 96, v143
    v_xor_b32 v139, 112, v143
    v_add_u32 v7, 2, v5
    v_subrev_u32 v8, 2, v5
    v_mov_b32 v9, v5
    v_cmp_lt_u32 vcc, 25, v5
    s_nop 1
    v_cndmask_b32 v9, v9, v7, vcc
    v_cmp_lt_u32 vcc, 27, v5
    s_nop 1
    v_cndmask_b32 v9, v9, v8, vcc
    v_cmp_lt_u32 vcc, 29, v5
    s_nop 1
    v_cndmask_b32 v9, v9, v5, vcc
    v_lshlrev_b32 v7, 5, v6
    v_add_u32 v9, v9, v7
    v_lshlrev_b32 v9, 4, v9
    s_lshl_b32 s91, s56, 11
    s_add_u32 s91, s91, 32768
    v_add_u32 v2, s91, v9
    v_and_b32 v7, 1, v5
    v_subrev_u32 v7, 1, v7
    v_and_b32 v132, 0x3f803f80, v7
    v_mov_b32 v133, v132
    v_mov_b32 v134, v132
    v_mov_b32 v135, v132
    s_add_u32 m0, s68, 49152
    s_add_u32 s65, s64, 896
    buffer_load_dwordx4 v108, s[32:35], s64 offen lds
    v_mov_b32 v7, 161536
    v_mov_b32 v8, 0
    ds_write_b32 v7, v8
    v_mov_b32 v3, 0x3fb8aa3b
    v_mov_b32 v131, v108
    v_and_b32 v5, 15, v1
    v_lshrrev_b32 v7, 2, v5
    v_and_b32 v5, 3, v5
    v_and_b32 v8, 16, v1
    v_lshrrev_b32 v8, 2, v8
    v_add_u32 v5, v5, v8
    s_and_b32 s90, s56, 1
    s_lshl_b32 s90, s90, 3
    v_add_u32 v5, s90, v5
    v_lshlrev_b32 v8, 2, v6
    v_add_u32 v7, v7, v8
    v_and_b32 v8, 5, v7
    v_and_b32 v9, 2, v7
    v_lshlrev_b32 v9, 2, v9
    v_or_b32 v8, v8, v9
    v_xor_b32 v8, v8, v5
    v_lshlrev_b32 v8, 3, v8
    v_lshlrev_b32 v9, 7, v7
    v_add_u32 v8, v8, v9
    s_lshr_b32 s90, s56, 1
    s_and_b32 s90, s90, 1
    s_lshl_b32 s91, s90, 14
    s_add_u32 s91, s91, 0
    s_add_u32 m0, s68, 57344
    s_add_u32 s64, s64, s77
    buffer_load_dwordx4 v108, s[32:35], s65 offen lds
    v_add_u32 v128, s91, v8
    v_xor_b32 v129, 16, v128
    v_add_u32 v129, 1024, v129
    s_lshl_b32 s90, s90, 13
    s_add_u32 s90, s90, 32768
    v_add_u32 v130, s90, v14
    v_lshrrev_b32 v5, 3, v1
    v_and_b32 v6, 7, v1
    v_and_b32 v7, 2, v5
    v_lshlrev_b32 v8, 1, v7
    v_xor_b32 v8, v6, v8
    v_lshlrev_b32 v8, 4, v8
    v_mul_u32_u24 v9, 896, v5
    v_add_u32 v4, v9, v8
    s_min_u32 s90, s70, 27
    s_mul_i32 s91, s90, 37
    s_lshr_b32 s91, s91, 8
    s_lshl_b32 s81, s89, 2
    s_add_u32 s81, s81, s91
    s_mul_i32 s91, s91, 7
    s_sub_u32 s88, s90, s91
    s_lshl_b32 s82, s88, 7
    s_mul_i32 s93, s56, 7168
    s_add_u32 s93, s93, s82
    s_sub_u32 s72, s93, 28672
    s_sub_u32 s71, s68, 4096
    s_mov_b32 s79, 0x00003f80
    s_mov_b32 s80, 0x3f800000
    s_mov_b32 s36, s26
    s_mov_b32 s37, s27
    s_mov_b32 s38, 8388608
    s_mov_b32 s39, 0x00020000
    s_mov_b32 s48, s22
    s_mov_b32 s49, s23
    s_mov_b32 s50, 1835008
    s_mov_b32 s51, 0x00020000
    s_mov_b32 s40, s10
    s_mov_b32 s41, s11
    s_mov_b32 s42, 401408
    s_mov_b32 s43, 0x00020000
    s_mov_b32 s44, s18
    s_mov_b32 s45, s19
    s_mov_b32 s46, 401408
    s_mov_b32 s47, 0x00020000
    s_waitcnt vmcnt(4) lgkmcnt(0)
    s_barrier
    ds_read_b128 v[144:147], v96 offset:0
    ds_read_b64_tr_b16 v[48:49], v104 offset:16384
    ds_read_b64_tr_b16 v[50:51], v104 offset:16896
    ds_read_b64_tr_b16 v[52:53], v104 offset:24576
    ds_read_b64_tr_b16 v[54:55], v104 offset:25088
    ds_read_b128 v[148:151], v97 offset:0
    ds_read_b64_tr_b16 v[56:57], v104 offset:18432
    ds_read_b64_tr_b16 v[58:59], v104 offset:18944
    ds_read_b64_tr_b16 v[60:61], v104 offset:26624
    ds_read_b64_tr_b16 v[62:63], v104 offset:27136
    ds_read_b128 v[152:155], v98 offset:0
    ds_read_b64_tr_b16 v[64:65], v104 offset:20480
    ds_read_b64_tr_b16 v[66:67], v104 offset:20992
    ds_read_b64_tr_b16 v[68:69], v104 offset:28672
    ds_read_b64_tr_b16 v[70:71], v104 offset:29184
    s_waitcnt lgkmcnt(10)
    v_mfma_f32_32x32x16_bf16 v[16:31], v[48:51], v[144:147], 0
    v_mfma_f32_32x32x16_bf16 v[32:47], v[144:147], v[52:55], 0
    ds_read_b128 v[156:159], v99 offset:0
    ds_read_b64_tr_b16 v[72:73], v104 offset:22528
    ds_read_b64_tr_b16 v[74:75], v104 offset:23040
    ds_read_b64_tr_b16 v[76:77], v104 offset:30720
    ds_read_b64_tr_b16 v[78:79], v104 offset:31232
    s_add_u32 m0, s67, 65536
    s_cmp_eq_u32 s62, 3
    buffer_load_dwordx4 v106, s[28:31], s63 offen lds
    s_cselect_b32 s76, 0xfffffd00, s94
    s_cselect_b32 s77, 0xfff04000, s95
    s_waitcnt lgkmcnt(10)
    v_mfma_f32_32x32x16_bf16 v[16:31], v[56:59], v[148:151], v[16:31]
    v_mfma_f32_32x32x16_bf16 v[32:47], v[148:151], v[60:63], v[32:47]
    s_add_u32 m0, s67, 66560
    s_sub_u32 s6, s64, 896
    buffer_load_dwordx4 v107, s[28:31], s63 offen lds
    s_add_u32 s63, s63, s76
    s_waitcnt lgkmcnt(5)
    v_mfma_f32_32x32x16_bf16 v[16:31], v[64:67], v[152:155], v[16:31]
    v_mfma_f32_32x32x16_bf16 v[32:47], v[152:155], v[68:71], v[32:47]
    s_add_u32 m0, s68, 81920
    s_add_u32 s65, s64, 896
    buffer_load_dwordx4 v108, s[32:35], s64 offen lds
    s_waitcnt lgkmcnt(0)
    v_mfma_f32_32x32x16_bf16 v[16:31], v[72:75], v[156:159], v[16:31]
    v_mfma_f32_32x32x16_bf16 v[32:47], v[156:159], v[76:79], v[32:47]
    s_add_u32 m0, s68, 90112
    s_add_u32 s64, s64, s77
    buffer_load_dwordx4 v108, s[32:35], s65 offen lds
    s_cmp_ge_u32 s56, 4
    s_cbranch_scc1 L_gate_dma
    s_cmp_eq_u32 s58, 0
    s_cselect_b32 s52, s8, s16
    s_cselect_b32 s53, s9, s17
    s_mov_b32 s54, 25088
    s_mov_b32 s55, 0x00020000
    s_mul_i32 s65, s59, 3136
    s_lshl_b32 s66, s56, 10
    s_add_u32 s65, s65, s66
    s_add_u32 m0, s66, 155648
    s_nop 0
    buffer_load_dwordx4 v14, s[52:55], s65 offen lds
    s_branch L_gate_done
L_gate_dma:
    s_mov_b32 s52, s20
    s_mov_b32 s53, s21
    s_mov_b32 s54, 896
    s_mov_b32 s55, 0x00020000
    s_and_b32 s66, s56, 1
    s_mul_i32 s66, s66, 896
    s_add_u32 m0, s66, 159744
    s_mov_b32 exec_lo, -1
    s_mov_b32 exec_hi, 0x00ffffff
    buffer_load_dwordx4 v14, s[52:55], 0 offen lds
    s_mov_b64 exec, -1
L_gate_done:
    s_waitcnt vmcnt(5) lgkmcnt(0)
    s_barrier
    ds_read_b128 v[160:163], v96 offset:32768
    ds_read_b64_tr_b16 v[48:49], v104 offset:49152
    ds_read_b64_tr_b16 v[50:51], v104 offset:49664
    ds_read_b64_tr_b16 v[52:53], v104 offset:57344
    ds_read_b64_tr_b16 v[54:55], v104 offset:57856
    ds_read_b128 v[164:167], v97 offset:32768
    ds_read_b64_tr_b16 v[56:57], v104 offset:51200
    ds_read_b64_tr_b16 v[58:59], v104 offset:51712
    ds_read_b64_tr_b16 v[60:61], v104 offset:59392
    ds_read_b64_tr_b16 v[62:63], v104 offset:59904
    ds_read_b128 v[168:171], v98 offset:32768
    ds_read_b64_tr_b16 v[64:65], v104 offset:53248
    ds_read_b64_tr_b16 v[66:67], v104 offset:53760
    ds_read_b64_tr_b16 v[68:69], v104 offset:61440
    ds_read_b64_tr_b16 v[70:71], v104 offset:61952
    s_waitcnt lgkmcnt(10)
    v_mfma_f32_32x32x16_bf16 v[16:31], v[48:51], v[160:163], v[16:31]
    v_mfma_f32_32x32x16_bf16 v[32:47], v[160:163], v[52:55], v[32:47]
    ds_read_b128 v[172:175], v99 offset:32768
    ds_read_b64_tr_b16 v[72:73], v104 offset:55296
    ds_read_b64_tr_b16 v[74:75], v104 offset:55808
    ds_read_b64_tr_b16 v[76:77], v104 offset:63488
    ds_read_b64_tr_b16 v[78:79], v104 offset:64000
    s_add_u32 m0, s67, 98304
    s_cmp_eq_u32 s62, 4
    buffer_load_dwordx4 v106, s[28:31], s63 offen lds
    s_cselect_b32 s76, 0xfffffd00, s94
    s_cselect_b32 s77, 0xfff04000, s95
    s_waitcnt lgkmcnt(10)
    v_mfma_f32_32x32x16_bf16 v[16:31], v[56:59], v[164:167], v[16:31]
    v_mfma_f32_32x32x16_bf16 v[32:47], v[164:167], v[60:63], v[32:47]
    s_add_u32 m0, s67, 99328
    s_sub_u32 s7, s64, 896
    buffer_load_dwordx4 v107, s[28:31], s63 offen lds
    s_add_u32 s63, s63, s76
    s_waitcnt lgkmcnt(5)
    v_mfma_f32_32x32x16_bf16 v[16:31], v[64:67], v[168:171], v[16:31]
    v_mfma_f32_32x32x16_bf16 v[32:47], v[168:171], v[68:71], v[32:47]
    s_add_u32 m0, s68, 114688
    s_add_u32 s65, s64, 896
    buffer_load_dwordx4 v108, s[32:35], s64 offen lds
    s_waitcnt lgkmcnt(0)
    v_mfma_f32_32x32x16_bf16 v[16:31], v[72:75], v[172:175], v[16:31]
    v_mfma_f32_32x32x16_bf16 v[32:47], v[172:175], v[76:79], v[32:47]
    s_add_u32 m0, s68, 122880
    s_add_u32 s64, s64, s77
    buffer_load_dwordx4 v108, s[32:35], s65 offen lds
    s_waitcnt vmcnt(5) lgkmcnt(0)
    s_barrier
    ds_read_b128 v[176:179], v100 offset:0
    ds_read_b64_tr_b16 v[48:49], v105 offset:16384
    ds_read_b64_tr_b16 v[50:51], v105 offset:16896
    ds_read_b64_tr_b16 v[52:53], v105 offset:24576
    ds_read_b64_tr_b16 v[54:55], v105 offset:25088
    ds_read_b128 v[180:183], v101 offset:0
    ds_read_b64_tr_b16 v[56:57], v105 offset:18432
    ds_read_b64_tr_b16 v[58:59], v105 offset:18944
    ds_read_b64_tr_b16 v[60:61], v105 offset:26624
    ds_read_b64_tr_b16 v[62:63], v105 offset:27136
    ds_read_b128 v[184:187], v102 offset:0
    ds_read_b64_tr_b16 v[64:65], v105 offset:20480
    ds_read_b64_tr_b16 v[66:67], v105 offset:20992
    ds_read_b64_tr_b16 v[68:69], v105 offset:28672
    ds_read_b64_tr_b16 v[70:71], v105 offset:29184
    s_waitcnt lgkmcnt(10)
    v_mfma_f32_32x32x16_bf16 v[16:31], v[48:51], v[176:179], v[16:31]
    v_mfma_f32_32x32x16_bf16 v[32:47], v[176:179], v[52:55], v[32:47]
    ds_read_b128 v[188:191], v103 offset:0
    ds_read_b64_tr_b16 v[72:73], v105 offset:22528
    ds_read_b64_tr_b16 v[74:75], v105 offset:23040
    ds_read_b64_tr_b16 v[76:77], v105 offset:30720
    ds_read_b64_tr_b16 v[78:79], v105 offset:31232
    s_add_u32 m0, s67, 0
    s_cmp_eq_u32 s62, 5
    buffer_load_dwordx4 v106, s[28:31], s63 offen lds
    s_cselect_b32 s76, 0xfffffd00, s94
    s_cselect_b32 s77, 0xfff04000, s95
    s_waitcnt lgkmcnt(10)
    v_mfma_f32_32x32x16_bf16 v[16:31], v[56:59], v[180:183], v[16:31]
    v_mfma_f32_32x32x16_bf16 v[32:47], v[180:183], v[60:63], v[32:47]
    s_add_u32 m0, s67, 1024
    s_sub_u32 s12, s64, 896
    buffer_load_dwordx4 v107, s[28:31], s63 offen lds
    s_add_u32 s63, s63, s76
    s_waitcnt lgkmcnt(5)
    v_mfma_f32_32x32x16_bf16 v[16:31], v[64:67], v[184:187], v[16:31]
    v_mfma_f32_32x32x16_bf16 v[32:47], v[184:187], v[68:71], v[32:47]
    s_add_u32 m0, s68, 16384
    s_add_u32 s65, s64, 896
    buffer_load_dwordx4 v108, s[32:35], s64 offen lds
    s_waitcnt lgkmcnt(0)
    v_mfma_f32_32x32x16_bf16 v[16:31], v[72:75], v[188:191], v[16:31]
    v_mfma_f32_32x32x16_bf16 v[32:47], v[188:191], v[76:79], v[32:47]
    s_add_u32 m0, s68, 24576
    s_add_u32 s64, s64, s77
    buffer_load_dwordx4 v108, s[32:35], s65 offen lds
    v_lshlrev_b32 v13, 21, v1
    v_min_u32 v13, 0x600000, v13
    v_add_u32 v13, 16384, v13
    buffer_load_dword v12, v13, s[36:39], 0 offen sc0 sc1
    s_waitcnt vmcnt(5) lgkmcnt(0)
    s_barrier
    ds_read_b128 v[192:195], v100 offset:32768
    ds_read_b64_tr_b16 v[48:49], v105 offset:49152
    ds_read_b64_tr_b16 v[50:51], v105 offset:49664
    ds_read_b64_tr_b16 v[52:53], v105 offset:57344
    ds_read_b64_tr_b16 v[54:55], v105 offset:57856
    ds_read_b128 v[196:199], v101 offset:32768
    ds_read_b64_tr_b16 v[56:57], v105 offset:51200
    ds_read_b64_tr_b16 v[58:59], v105 offset:51712
    ds_read_b64_tr_b16 v[60:61], v105 offset:59392
    ds_read_b64_tr_b16 v[62:63], v105 offset:59904
    ds_read_b128 v[200:203], v102 offset:32768
    ds_read_b64_tr_b16 v[64:65], v105 offset:53248
    ds_read_b64_tr_b16 v[66:67], v105 offset:53760
    ds_read_b64_tr_b16 v[68:69], v105 offset:61440
    ds_read_b64_tr_b16 v[70:71], v105 offset:61952
    s_waitcnt lgkmcnt(10)
    v_mfma_f32_32x32x16_bf16 v[16:31], v[48:51], v[192:195], v[16:31]
    v_mfma_f32_32x32x16_bf16 v[32:47], v[192:195], v[52:55], v[32:47]
    ds_read_b128 v[204:207], v103 offset:32768
    ds_read_b64_tr_b16 v[72:73], v105 offset:55296
    ds_read_b64_tr_b16 v[74:75], v105 offset:55808
    ds_read_b64_tr_b16 v[76:77], v105 offset:63488
    ds_read_b64_tr_b16 v[78:79], v105 offset:64000
    s_add_u32 m0, s67, 32768
    s_cmp_eq_u32 s62, 6
    buffer_load_dwordx4 v106, s[28:31], s63 offen lds
    s_cselect_b32 s76, 0xfffffd00, s94
    s_cselect_b32 s77, 0xfff04000, s95
    s_waitcnt lgkmcnt(10)
    v_mfma_f32_32x32x16_bf16 v[16:31], v[56:59], v[196:199], v[16:31]
    v_mfma_f32_32x32x16_bf16 v[32:47], v[196:199], v[60:63], v[32:47]
    s_add_u32 m0, s67, 33792
    s_sub_u32 s13, s64, 896
    buffer_load_dwordx4 v107, s[28:31], s63 offen lds
    s_add_u32 s63, s63, s76
    s_waitcnt lgkmcnt(5)
    v_mfma_f32_32x32x16_bf16 v[16:31], v[64:67], v[200:203], v[16:31]
    v_mfma_f32_32x32x16_bf16 v[32:47], v[200:203], v[68:71], v[32:47]
    s_add_u32 m0, s68, 49152
    s_add_u32 s65, s64, 896
    buffer_load_dwordx4 v108, s[32:35], s64 offen lds
    s_waitcnt lgkmcnt(0)
    v_mfma_f32_32x32x16_bf16 v[16:31], v[72:75], v[204:207], v[16:31]
    v_mfma_f32_32x32x16_bf16 v[32:47], v[204:207], v[76:79], v[32:47]
    s_add_u32 m0, s68, 57344
    s_add_u32 s64, s64, s77
    buffer_load_dwordx4 v108, s[32:35], s65 offen lds
    s_waitcnt vmcnt(5) lgkmcnt(0)
    s_barrier
    ds_read_b128 v[208:211], v96 offset:0
    ds_read_b64_tr_b16 v[48:49], v104 offset:16384
    ds_read_b64_tr_b16 v[50:51], v104 offset:16896
    ds_read_b64_tr_b16 v[52:53], v104 offset:24576
    ds_read_b64_tr_b16 v[54:55], v104 offset:25088
    ds_read_b128 v[212:215], v97 offset:0
    ds_read_b64_tr_b16 v[56:57], v104 offset:18432
    ds_read_b64_tr_b16 v[58:59], v104 offset:18944
    ds_read_b64_tr_b16 v[60:61], v104 offset:26624
    ds_read_b64_tr_b16 v[62:63], v104 offset:27136
    ds_read_b128 v[216:219], v98 offset:0
    ds_read_b64_tr_b16 v[64:65], v104 offset:20480
    ds_read_b64_tr_b16 v[66:67], v104 offset:20992
    ds_read_b64_tr_b16 v[68:69], v104 offset:28672
    ds_read_b64_tr_b16 v[70:71], v104 offset:29184
    s_waitcnt lgkmcnt(10)
    v_mfma_f32_32x32x16_bf16 v[16:31], v[48:51], v[208:211], v[16:31]
    v_mfma_f32_32x32x16_bf16 v[32:47], v[208:211], v[52:55], v[32:47]
    ds_read_b128 v[220:223], v99 offset:0
    ds_read_b64_tr_b16 v[72:73], v104 offset:22528
    ds_read_b64_tr_b16 v[74:75], v104 offset:23040
    ds_read_b64_tr_b16 v[76:77], v104 offset:30720
    ds_read_b64_tr_b16 v[78:79], v104 offset:31232
    s_add_u32 m0, s67, 65536
    s_cmp_eq_u32 s62, 7
    buffer_load_dwordx4 v106, s[28:31], s63 offen lds
    s_cselect_b32 s76, 0xfffffd00, s94
    s_cselect_b32 s77, 0xfff04000, s95
    s_waitcnt lgkmcnt(10)
    v_mfma_f32_32x32x16_bf16 v[16:31], v[56:59], v[212:215], v[16:31]
    v_mfma_f32_32x32x16_bf16 v[32:47], v[212:215], v[60:63], v[32:47]
    s_add_u32 m0, s67, 66560
    s_sub_u32 s14, s64, 896
    buffer_load_dwordx4 v107, s[28:31], s63 offen lds
    s_add_u32 s63, s63, s76
    s_waitcnt lgkmcnt(5)
    v_mfma_f32_32x32x16_bf16 v[16:31], v[64:67], v[216:219], v[16:31]
    v_mfma_f32_32x32x16_bf16 v[32:47], v[216:219], v[68:71], v[32:47]
    s_add_u32 m0, s68, 81920
    s_add_u32 s65, s64, 896
    buffer_load_dwordx4 v108, s[32:35], s64 offen lds
    v_and_b32 v5, 15, v1
    v_lshrrev_b32 v6, 2, v5
    v_and_b32 v5, 3, v5
    v_and_b32 v7, 16, v1
    v_lshrrev_b32 v7, 2, v7
    v_add_u32 v5, v5, v7
    v_min_u32 v5, 6, v5
    v_lshlrev_b32 v5, 3, v5
    v_lshrrev_b32 v7, 5, v1
    v_lshlrev_b32 v7, 2, v7
    v_add_u32 v6, v6, v7
    v_mul_u32_u24 v6, 56, v6
    v_add_u32 v5, v5, v6
    s_lshr_b32 s90, s56, 2
    s_mul_i32 s90, s90, 1568
    s_add_u32 s90, s90, 155648
    v_add_u32 v5, s90, v5
    ds_read_b64_tr_b16 v[80:81], v5 offset:0
    ds_read_b64_tr_b16 v[82:83], v5 offset:448
    ds_read_b64_tr_b16 v[84:85], v5 offset:896
    ds_read_b64_tr_b16 v[86:87], v5 offset:1344
    s_waitcnt lgkmcnt(4)
    v_mfma_f32_32x32x16_bf16 v[16:31], v[72:75], v[220:223], v[16:31]
    v_mfma_f32_32x32x16_bf16 v[32:47], v[220:223], v[76:79], v[32:47]
    s_add_u32 m0, s68, 90112
    s_add_u32 s64, s64, s77
    buffer_load_dwordx4 v108, s[32:35], s65 offen lds
    s_waitcnt lgkmcnt(0)
    v_mov_b32_dpp v80, v80 row_shr:2 row_mask:0xa bank_mask:0x8
    v_mov_b32_dpp v81, v81 row_shr:2 row_mask:0xa bank_mask:0x8
    v_mov_b32_dpp v82, v82 row_shr:2 row_mask:0xa bank_mask:0x8
    v_mov_b32_dpp v83, v83 row_shr:2 row_mask:0xa bank_mask:0x8
    v_mov_b32_dpp v84, v84 row_shr:2 row_mask:0xa bank_mask:0x8
    v_mov_b32_dpp v85, v85 row_shr:2 row_mask:0xa bank_mask:0x8
    v_mov_b32_dpp v86, v86 row_shr:2 row_mask:0xa bank_mask:0x8
    v_mov_b32_dpp v87, v87 row_shr:2 row_mask:0xa bank_mask:0x8
    s_mov_b32 exec_lo, 0
    v_mov_b32 v86, 0
    v_mov_b32 v87, 0
    s_mov_b64 exec, -1
    s_waitcnt vmcnt(4) lgkmcnt(0)
    s_barrier
    ds_read_b128 v[224:227], v96 offset:32768
    ds_read_b64_tr_b16 v[48:49], v104 offset:49152
    ds_read_b64_tr_b16 v[50:51], v104 offset:49664
    ds_read_b64_tr_b16 v[52:53], v104 offset:57344
    ds_read_b64_tr_b16 v[54:55], v104 offset:57856
    ds_read_b128 v[228:231], v97 offset:32768
    ds_read_b64_tr_b16 v[56:57], v104 offset:51200
    ds_read_b64_tr_b16 v[58:59], v104 offset:51712
    ds_read_b64_tr_b16 v[60:61], v104 offset:59392
    ds_read_b64_tr_b16 v[62:63], v104 offset:59904
    ds_read_b128 v[232:235], v98 offset:32768
    ds_read_b64_tr_b16 v[64:65], v104 offset:53248
    ds_read_b64_tr_b16 v[66:67], v104 offset:53760
    ds_read_b64_tr_b16 v[68:69], v104 offset:61440
    ds_read_b64_tr_b16 v[70:71], v104 offset:61952
    s_waitcnt lgkmcnt(10)
    v_mfma_f32_32x32x16_bf16 v[16:31], v[48:51], v[224:227], v[16:31]
    v_mfma_f32_32x32x16_bf16 v[32:47], v[224:227], v[52:55], v[32:47]
    ds_read_b128 v[236:239], v99 offset:32768
    ds_read_b64_tr_b16 v[72:73], v104 offset:55296
    ds_read_b64_tr_b16 v[74:75], v104 offset:55808
    ds_read_b64_tr_b16 v[76:77], v104 offset:63488
    ds_read_b64_tr_b16 v[78:79], v104 offset:64000
    s_add_u32 m0, s68, 131072
    s_nop 0
    buffer_load_dwordx4 v108, s[32:35], s12 offen lds
    s_waitcnt lgkmcnt(10)
    v_mfma_f32_32x32x16_bf16 v[16:31], v[56:59], v[228:231], v[16:31]
    v_mfma_f32_32x32x16_bf16 v[32:47], v[228:231], v[60:63], v[32:47]
    s_add_u32 m0, s68, 139264
    s_nop 0
    buffer_load_dwordx4 v108, s[32:35], s13 offen lds
    s_waitcnt lgkmcnt(5)
    v_mfma_f32_32x32x16_bf16 v[16:31], v[64:67], v[232:235], v[16:31]
    v_mfma_f32_32x32x16_bf16 v[32:47], v[232:235], v[68:71], v[32:47]
    s_add_u32 m0, s68, 147456
    s_nop 0
    buffer_load_dwordx4 v108, s[32:35], s14 offen lds
    s_waitcnt lgkmcnt(0)
    v_mfma_f32_32x32x16_bf16 v[16:31], v[72:75], v[236:239], v[16:31]
    v_mfma_f32_32x32x16_bf16 v[32:47], v[236:239], v[76:79], v[32:47]
    s_add_u32 m0, s68, 98304
    s_nop 0
    buffer_load_dwordx4 v108, s[32:35], s4 offen lds
    s_waitcnt vmcnt(4) lgkmcnt(0)
    s_barrier
    ds_read_b128 v[240:243], v100 offset:0
    ds_read_b64_tr_b16 v[48:49], v105 offset:16384
    ds_read_b64_tr_b16 v[50:51], v105 offset:16896
    ds_read_b64_tr_b16 v[52:53], v105 offset:24576
    ds_read_b64_tr_b16 v[54:55], v105 offset:25088
    ds_read_b128 v[244:247], v101 offset:0
    ds_read_b64_tr_b16 v[56:57], v105 offset:18432
    ds_read_b64_tr_b16 v[58:59], v105 offset:18944
    ds_read_b64_tr_b16 v[60:61], v105 offset:26624
    ds_read_b64_tr_b16 v[62:63], v105 offset:27136
    ds_read_b128 v[248:251], v102 offset:0
    ds_read_b64_tr_b16 v[64:65], v105 offset:20480
    ds_read_b64_tr_b16 v[66:67], v105 offset:20992
    ds_read_b64_tr_b16 v[68:69], v105 offset:28672
    ds_read_b64_tr_b16 v[70:71], v105 offset:29184
    s_waitcnt lgkmcnt(10)
    v_mfma_f32_32x32x16_bf16 v[16:31], v[48:51], v[240:243], v[16:31]
    v_mfma_f32_32x32x16_bf16 v[32:47], v[240:243], v[52:55], v[32:47]
    ds_read_b128 v[252:255], v103 offset:0
    ds_read_b64_tr_b16 v[72:73], v105 offset:22528
    ds_read_b64_tr_b16 v[74:75], v105 offset:23040
    ds_read_b64_tr_b16 v[76:77], v105 offset:30720
    ds_read_b64_tr_b16 v[78:79], v105 offset:31232
    s_waitcnt lgkmcnt(10)
    v_mfma_f32_32x32x16_bf16 v[16:31], v[56:59], v[244:247], v[16:31]
    v_mfma_f32_32x32x16_bf16 v[32:47], v[244:247], v[60:63], v[32:47]
    s_waitcnt lgkmcnt(5)
    v_mfma_f32_32x32x16_bf16 v[16:31], v[64:67], v[248:251], v[16:31]
    v_mfma_f32_32x32x16_bf16 v[32:47], v[248:251], v[68:71], v[32:47]
    s_mov_b32 exec_lo, 0xf0000000
    s_mov_b32 exec_hi, 0xf0000000
    ds_write_b128 v2, v[132:135]
    ds_write_b128 v2, v[132:135] offset:1024
    s_mov_b64 exec, -1
    s_waitcnt lgkmcnt(2)
    v_mfma_f32_32x32x16_bf16 v[16:31], v[72:75], v[252:255], v[16:31]
    v_mfma_f32_32x32x16_bf16 v[32:47], v[252:255], v[76:79], v[32:47]
    s_mov_b32 s74, 0x0fffffff
    s_mov_b32 s75, 0x0fffffff
    s_nop 8
    v_cvt_pk_bf16_f32 v88, v16, v17
    v_cvt_pk_bf16_f32 v89, v18, v19
    v_cvt_pk_bf16_f32 v90, v20, v21
    v_cvt_pk_bf16_f32 v91, v22, v23
    v_cvt_pk_bf16_f32 v92, v24, v25
    v_cvt_pk_bf16_f32 v93, v26, v27
    v_cvt_pk_bf16_f32 v94, v28, v29
    v_cvt_pk_bf16_f32 v95, v30, v31
    s_nop 1
    v_mfma_f32_32x32x16_bf16 v[16:31], v[80:83], v[88:91], 0
    v_mfma_f32_32x32x16_bf16 v[16:31], v[84:87], v[92:95], v[16:31]
    v_cvt_pk_bf16_f32 v48, v32, v33
    v_cvt_pk_bf16_f32 v49, v34, v35
    v_cvt_pk_bf16_f32 v50, v36, v37
    v_cvt_pk_bf16_f32 v51, v38, v39
    v_cvt_pk_bf16_f32 v52, v40, v41
    v_cvt_pk_bf16_f32 v53, v42, v43
    v_cvt_pk_bf16_f32 v54, v44, v45
    v_cvt_pk_bf16_f32 v55, v46, v47
    s_mov_b64 exec, s[74:75]
    ds_write_b128 v2, v[48:51]
    ds_write_b128 v2, v[52:55] offset:1024
    s_mov_b64 exec, -1
    v_max3_f32 v7, v16, v17, v18
    v_min3_f32 v6, v16, v17, v18
    v_max3_f32 v8, v19, v20, v21
    v_min3_f32 v11, v19, v20, v21
    v_max3_f32 v9, v22, v23, v24
    v_min3_f32 v13, v22, v23, v24
    v_max3_f32 v10, v25, v26, v27
    v_min3_f32 v5, v25, v26, v27
    v_max3_f32 v7, v28, v29, v7
    v_min3_f32 v6, v28, v29, v6
    v_max3_f32 v8, v8, v9, v10
    v_min3_f32 v11, v11, v13, v5
    v_max_f32 v5, v7, v8
    v_min_f32 v6, v6, v11
    v_mul_f32_e64 v5, -v3, v5
    v_mul_f32 v6, v3, v6
    s_nop 1
    v_permlane32_swap_b32 v5, v6
    s_nop 1
    v_min_f32 v5, v5, v6
    v_mov_b32 v6, v5
    s_nop 1
    v_permlane32_swap_b32 v5, v6
    s_nop 1
    v_fma_f32 v96, v16, v3, v5
    v_fma_f32 v110, v16, -v3, v6
    v_fma_f32 v97, v17, v3, v5
    v_fma_f32 v111, v17, -v3, v6
    v_fma_f32 v98, v18, v3, v5
    v_fma_f32 v112, v18, -v3, v6
    v_fma_f32 v99, v19, v3, v5
    v_fma_f32 v113, v19, -v3, v6
    v_fma_f32 v100, v20, v3, v5
    v_fma_f32 v114, v20, -v3, v6
    v_fma_f32 v101, v21, v3, v5
    v_fma_f32 v115, v21, -v3, v6
    v_fma_f32 v102, v22, v3, v5
    v_fma_f32 v116, v22, -v3, v6
    v_fma_f32 v103, v23, v3, v5
    v_fma_f32 v117, v23, -v3, v6
    v_fma_f32 v104, v24, v3, v5
    v_fma_f32 v118, v24, -v3, v6
    v_fma_f32 v105, v25, v3, v5
    v_fma_f32 v119, v25, -v3, v6
    v_fma_f32 v106, v26, v3, v5
    v_fma_f32 v120, v26, -v3, v6
    v_fma_f32 v107, v27, v3, v5
    v_fma_f32 v121, v27, -v3, v6
    v_fma_f32 v108, v28, v3, v5
    v_fma_f32 v122, v28, -v3, v6
    v_fma_f32 v109, v29, v3, v5
    v_fma_f32 v123, v29, -v3, v6
    v_exp_f32 v96, v96
    v_exp_f32 v97, v97
    v_exp_f32 v98, v98
    v_exp_f32 v99, v99
    v_exp_f32 v100, v100
    v_exp_f32 v101, v101
    v_exp_f32 v102, v102
    v_exp_f32 v103, v103
    v_exp_f32 v104, v104
    v_exp_f32 v105, v105
    v_exp_f32 v106, v106
    v_exp_f32 v107, v107
    v_exp_f32 v108, v108
    v_exp_f32 v109, v109
    v_exp_f32 v110, v110
    v_exp_f32 v111, v111
    v_exp_f32 v112, v112
    v_exp_f32 v113, v113
    v_exp_f32 v114, v114
    v_exp_f32 v115, v115
    v_exp_f32 v116, v116
    v_exp_f32 v117, v117
    v_exp_f32 v118, v118
    v_exp_f32 v119, v119
    v_exp_f32 v120, v120
    v_exp_f32 v121, v121
    v_exp_f32 v122, v122
    v_exp_f32 v123, v123
    v_add_f32 v7, v96, v97
    v_add_f32 v8, v98, v99
    v_add_f32 v9, v100, v101
    v_add_f32 v10, v102, v103
    v_add_f32 v7, v7, v104
    v_add_f32 v8, v8, v105
    v_add_f32 v9, v9, v106
    v_add_f32 v10, v10, v107
    v_add_f32 v7, v7, v108
    v_add_f32 v8, v8, v109
    v_add_f32 v9, v9, v10
    v_add_f32 v7, v7, v8
    v_add_f32 v5, v7, v9
    v_add_f32 v7, v110, v111
    v_add_f32 v8, v112, v113
    v_add_f32 v9, v114, v115
    v_add_f32 v10, v116, v117
    v_add_f32 v7, v7, v118
    v_add_f32 v8, v8, v119
    v_add_f32 v9, v9, v120
    v_add_f32 v10, v10, v121
    v_add_f32 v7, v7, v122
    v_add_f32 v8, v8, v123
    v_add_f32 v9, v9, v10
    v_add_f32 v7, v7, v8
    v_add_f32 v6, v7, v9
    v_mov_b32 v63, 0
    v_mov_b32 v71, 0
    v_permlane32_swap_b32 v5, v6
    s_nop 1
    v_add_f32 v5, v5, v6
    v_rcp_f32 v5, v5
    s_nop 0
    v_mov_b32 v6, v5
    s_nop 1
    v_permlane32_swap_b32 v5, v6
    s_nop 1
    v_mul_f32 v96, v96, v5
    v_mul_f32 v97, v97, v5
    v_mul_f32 v98, v98, v5
    v_mul_f32 v99, v99, v5
    v_mul_f32 v100, v100, v5
    v_mul_f32 v101, v101, v5
    v_mul_f32 v102, v102, v5
    v_mul_f32 v103, v103, v5
    v_mul_f32 v104, v104, v5
    v_mul_f32 v105, v105, v5
    v_mul_f32 v106, v106, v5
    v_mul_f32 v107, v107, v5
    v_mul_f32 v108, v108, v5
    v_mul_f32 v109, v109, v5
    v_cvt_pk_bf16_f32 v56, v96, v97
    v_cvt_pk_bf16_f32 v57, v98, v99
    ds_write_b64 v124, v[56:57]
    v_cvt_pk_bf16_f32 v58, v100, v101
    v_cvt_pk_bf16_f32 v59, v102, v103
    ds_write_b64 v125, v[58:59]
    v_cvt_pk_bf16_f32 v60, v104, v105
    v_cvt_pk_bf16_f32 v61, v106, v107
    ds_write_b64 v126, v[60:61]
    v_cvt_pk_bf16_f32 v62, v108, v109
    ds_write_b64 v127, v[62:63]
    v_mul_f32 v110, v110, v6
    v_mul_f32 v111, v111, v6
    v_mul_f32 v112, v112, v6
    v_mul_f32 v113, v113, v6
    v_mul_f32 v114, v114, v6
    v_mul_f32 v115, v115, v6
    v_mul_f32 v116, v116, v6
    v_mul_f32 v117, v117, v6
    v_mul_f32 v118, v118, v6
    v_mul_f32 v119, v119, v6
    v_mul_f32 v120, v120, v6
    v_mul_f32 v121, v121, v6
    v_mul_f32 v122, v122, v6
    v_mul_f32 v123, v123, v6
    v_cvt_pk_bf16_f32 v64, v110, v111
    v_cvt_pk_bf16_f32 v65, v112, v113
    ds_write_b64 v136, v[64:65]
    v_cvt_pk_bf16_f32 v66, v114, v115
    v_cvt_pk_bf16_f32 v67, v116, v117
    ds_write_b64 v137, v[66:67]
    v_cvt_pk_bf16_f32 v68, v118, v119
    v_cvt_pk_bf16_f32 v69, v120, v121
    ds_write_b64 v138, v[68:69]
    v_cvt_pk_bf16_f32 v70, v122, v123
    ds_write_b64 v139, v[70:71]
    s_waitcnt vmcnt(0) lgkmcnt(0)
    s_barrier
    v_readfirstlane_b32 s69, v12
    s_cmp_ge_u32 s56, 4
    s_cbranch_scc1 L_c2_hi
    ds_read_b64_tr_b16 v[48:49], v128 offset:0
    ds_read_b64_tr_b16 v[50:51], v129 offset:0
    ds_read_b128 v[96:99], v130 offset:0
    ds_read_b64_tr_b16 v[52:53], v128 offset:2048
    ds_read_b64_tr_b16 v[54:55], v129 offset:2048
    ds_read_b128 v[100:103], v130 offset:1024
    ds_read_b64_tr_b16 v[56:57], v128 offset:4096
    ds_read_b64_tr_b16 v[58:59], v129 offset:4096
    ds_read_b128 v[104:107], v130 offset:2048
    ds_read_b64_tr_b16 v[60:61], v128 offset:6144
    ds_read_b64_tr_b16 v[62:63], v129 offset:6144
    ds_read_b128 v[108:111], v130 offset:3072
    ds_read_b64_tr_b16 v[64:65], v128 offset:8192
    ds_read_b64_tr_b16 v[66:67], v129 offset:8192
    ds_read_b128 v[112:115], v130 offset:4096
    s_lshl_b32 s65, s60, 4
    s_add_u32 s65, s65, s57
    s_lshl_b32 s65, s65, 3
    s_lshl_b32 s66, s56, 1
    s_add_u32 s65, s65, s66
    s_lshl_b32 s65, s65, 10
    s_add_u32 s65, s65, 1048576
    s_waitcnt lgkmcnt(12)
    v_mfma_f32_32x32x16_bf16 v[16:31], v[48:51], v[96:99], 0
    ds_read_b64_tr_b16 v[68:69], v128 offset:10240
    ds_read_b64_tr_b16 v[70:71], v129 offset:10240
    ds_read_b128 v[116:119], v130 offset:5120
    s_waitcnt lgkmcnt(12)
    v_mfma_f32_32x32x16_bf16 v[16:31], v[52:55], v[100:103], v[16:31]
    ds_read_b64_tr_b16 v[72:73], v128 offset:12288
    ds_read_b64_tr_b16 v[74:75], v129 offset:12288
    ds_read_b128 v[120:123], v130 offset:6144
    s_waitcnt lgkmcnt(12)
    v_mfma_f32_32x32x16_bf16 v[16:31], v[56:59], v[104:107], v[16:31]
    ds_read_b64_tr_b16 v[76:77], v128 offset:14336
    ds_read_b64_tr_b16 v[78:79], v129 offset:14336
    ds_read_b128 v[124:127], v130 offset:7168
    s_waitcnt lgkmcnt(12)
    v_mfma_f32_32x32x16_bf16 v[16:31], v[60:63], v[108:111], v[16:31]
    s_waitcnt lgkmcnt(9)
    v_mfma_f32_32x32x16_bf16 v[16:31], v[64:67], v[112:115], v[16:31]
    s_waitcnt lgkmcnt(6)
    v_mfma_f32_32x32x16_bf16 v[16:31], v[68:71], v[116:119], v[16:31]
    s_waitcnt lgkmcnt(3)
    v_mfma_f32_32x32x16_bf16 v[16:31], v[72:75], v[120:123], v[16:31]
    s_waitcnt lgkmcnt(0)
    v_mfma_f32_32x32x16_bf16 v[16:31], v[76:79], v[124:127], v[16:31]
    s_lshl_b32 s78, s60, 4
    s_add_u32 s78, s78, s57
    s_lshl_b32 s78, s78, 7
    s_add_u32 s78, s78, 65536
    v_mov_b32 v7, 161536
    v_mov_b32 v8, 1
    s_nop 5
    v_cvt_pk_bf16_f32 v88, v16, v17
    v_cvt_pk_bf16_f32 v89, v18, v19
    v_cvt_pk_bf16_f32 v90, v20, v21
    v_cvt_pk_bf16_f32 v91, v22, v23
    v_cvt_pk_bf16_f32 v92, v24, v25
    v_cvt_pk_bf16_f32 v93, v26, v27
    v_cvt_pk_bf16_f32 v94, v28, v29
    v_cvt_pk_bf16_f32 v95, v30, v31
    buffer_store_dwordx4 v[88:91], v14, s[36:39], s65 offen sc0 sc1
    buffer_store_dwordx4 v[92:95], v14, s[36:39], s65 offen offset:1024 sc0 sc1
    s_add_u32 s69, s69, 1
    s_mov_b32 s74, 0x10000000
    s_mov_b32 s75, 0x10000000
    ds_read_b64_tr_b16 v[48:49], v142 offset:32768
    ds_read_b64_tr_b16 v[50:51], v142 offset:33280
    s_mov_b64 exec, s[74:75]
    ds_read_b128 v[48:51], v141 offset:512
    s_mov_b64 exec, -1
    ds_read_b64_tr_b16 v[52:53], v142 offset:34816
    ds_read_b64_tr_b16 v[54:55], v142 offset:35328
    s_mov_b64 exec, s[74:75]
    ds_read_b128 v[52:55], v141 offset:544
    s_mov_b64 exec, -1
    ds_read_b64_tr_b16 v[56:57], v142 offset:36864
    ds_read_b64_tr_b16 v[58:59], v142 offset:37376
    s_mov_b64 exec, s[74:75]
    ds_read_b128 v[56:59], v141 offset:576
    s_mov_b64 exec, -1
    ds_read_b64_tr_b16 v[60:61], v142 offset:38912
    ds_read_b64_tr_b16 v[62:63], v142 offset:39424
    s_mov_b64 exec, s[74:75]
    ds_read_b128 v[60:63], v141 offset:608
    s_mov_b64 exec, -1
    ds_read_b64_tr_b16 v[64:65], v142 offset:40960
    ds_read_b64_tr_b16 v[66:67], v142 offset:41472
    s_mov_b64 exec, s[74:75]
    ds_read_b128 v[64:67], v141 offset:640
    s_mov_b64 exec, -1
    s_waitcnt vmcnt(0) lgkmcnt(0)
    s_mov_b64 exec, 1
    ds_add_rtn_u32 v5, v7, v8
    v_mov_b32 v6, s69
    s_waitcnt lgkmcnt(0)
    v_readfirstlane_b32 s90, v5
    v_mov_b32 v5, 0
    s_nop 2
    s_cmp_eq_u32 s90, 3
    s_cbranch_scc0 L_noflag1
    buffer_store_dword v6, v5, s[36:39], s78 offen sc0 sc1
L_noflag1:
    s_mov_b64 exec, -1
    s_barrier
    s_waitcnt lgkmcnt(12)
    v_mfma_f32_32x32x16_bf16 v[32:47], v[48:51], v[208:211], 0
    ds_read_b64_tr_b16 v[48:49], v142 offset:43008
    ds_read_b64_tr_b16 v[50:51], v142 offset:43520
    s_mov_b64 exec, s[74:75]
    ds_read_b128 v[48:51], v141 offset:672
    s_mov_b64 exec, -1
    s_waitcnt lgkmcnt(12)
    v_mfma_f32_32x32x16_bf16 v[32:47], v[52:55], v[212:215], v[32:47]
    ds_read_b64_tr_b16 v[52:53], v142 offset:45056
    ds_read_b64_tr_b16 v[54:55], v142 offset:45568
    s_mov_b64 exec, s[74:75]
    ds_read_b128 v[52:55], v141 offset:704
    s_mov_b64 exec, -1
    s_add_u32 m0, s68, 24576
    s_add_u32 s65, s93, 172032
    buffer_load_dwordx4 v4, s[40:43], s65 offen lds
    s_waitcnt lgkmcnt(12)
    v_mfma_f32_32x32x16_bf16 v[32:47], v[56:59], v[216:219], v[32:47]
    ds_read_b64_tr_b16 v[56:57], v142 offset:47104
    ds_read_b64_tr_b16 v[58:59], v142 offset:47616
    s_mov_b64 exec, s[74:75]
    ds_read_b128 v[56:59], v141 offset:736
    s_mov_b64 exec, -1
    s_waitcnt lgkmcnt(12)
    v_mfma_f32_32x32x16_bf16 v[32:47], v[60:63], v[220:223], v[32:47]
    ds_read_b64_tr_b16 v[60:61], v142 offset:49152
    ds_read_b64_tr_b16 v[62:63], v142 offset:49664
    s_mov_b64 exec, s[74:75]
    ds_read_b128 v[60:63], v141 offset:768
    s_mov_b64 exec, -1
    s_waitcnt lgkmcnt(12)
    v_mfma_f32_32x32x16_bf16 v[32:47], v[64:67], v[224:227], v[32:47]
    ds_read_b64_tr_b16 v[64:65], v142 offset:51200
    ds_read_b64_tr_b16 v[66:67], v142 offset:51712
    s_mov_b64 exec, s[74:75]
    ds_read_b128 v[64:67], v141 offset:800
    s_mov_b64 exec, -1
    s_waitcnt lgkmcnt(12)
    v_mfma_f32_32x32x16_bf16 v[32:47], v[48:51], v[228:231], v[32:47]
    ds_read_b64_tr_b16 v[48:49], v142 offset:53248
    ds_read_b64_tr_b16 v[50:51], v142 offset:53760
    s_mov_b64 exec, s[74:75]
    ds_read_b128 v[48:51], v141 offset:832
    s_mov_b64 exec, -1
    s_add_u32 m0, s68, 32768
    s_add_u32 s65, s93, 229376
    buffer_load_dwordx4 v4, s[40:43], s65 offen lds
    s_waitcnt lgkmcnt(12)
    v_mfma_f32_32x32x16_bf16 v[32:47], v[52:55], v[232:235], v[32:47]
    ds_read_b64_tr_b16 v[52:53], v142 offset:55296
    ds_read_b64_tr_b16 v[54:55], v142 offset:55808
    s_mov_b64 exec, s[74:75]
    ds_read_b128 v[52:55], v141 offset:864
    s_mov_b64 exec, -1
    s_waitcnt lgkmcnt(12)
    v_mfma_f32_32x32x16_bf16 v[32:47], v[56:59], v[236:239], v[32:47]
    ds_read_b64_tr_b16 v[56:57], v142 offset:0
    ds_read_b64_tr_b16 v[58:59], v142 offset:512
    s_mov_b64 exec, s[74:75]
    ds_read_b128 v[56:59], v141 offset:0
    s_mov_b64 exec, -1
    s_waitcnt lgkmcnt(12)
    v_mfma_f32_32x32x16_bf16 v[32:47], v[60:63], v[240:243], v[32:47]
    ds_read_b64_tr_b16 v[60:61], v142 offset:2048
    ds_read_b64_tr_b16 v[62:63], v142 offset:2560
    s_mov_b64 exec, s[74:75]
    ds_read_b128 v[60:63], v141 offset:32
    s_mov_b64 exec, -1
    s_waitcnt lgkmcnt(12)
    v_mfma_f32_32x32x16_bf16 v[32:47], v[64:67], v[244:247], v[32:47]
    ds_read_b64_tr_b16 v[64:65], v142 offset:4096
    ds_read_b64_tr_b16 v[66:67], v142 offset:4608
    s_mov_b64 exec, s[74:75]
    ds_read_b128 v[64:67], v141 offset:64
    s_mov_b64 exec, -1
    s_add_u32 m0, s68, 40960
    s_add_u32 s65, s93, 286720
    buffer_load_dwordx4 v4, s[40:43], s65 offen lds
    s_waitcnt lgkmcnt(12)
    v_mfma_f32_32x32x16_bf16 v[32:47], v[48:51], v[248:251], v[32:47]
    ds_read_b64_tr_b16 v[48:49], v142 offset:6144
    ds_read_b64_tr_b16 v[50:51], v142 offset:6656
    s_mov_b64 exec, s[74:75]
    ds_read_b128 v[48:51], v141 offset:96
    s_mov_b64 exec, -1
    s_waitcnt lgkmcnt(12)
    v_mfma_f32_32x32x16_bf16 v[32:47], v[52:55], v[252:255], v[32:47]
    ds_read_b64_tr_b16 v[52:53], v142 offset:8192
    ds_read_b64_tr_b16 v[54:55], v142 offset:8704
    s_mov_b64 exec, s[74:75]
    ds_read_b128 v[52:55], v141 offset:128
    s_mov_b64 exec, -1
    s_waitcnt lgkmcnt(12)
    v_mfma_f32_32x32x16_bf16 v[32:47], v[56:59], v[144:147], v[32:47]
    ds_read_b64_tr_b16 v[56:57], v142 offset:10240
    ds_read_b64_tr_b16 v[58:59], v142 offset:10752
    s_mov_b64 exec, s[74:75]
    ds_read_b128 v[56:59], v141 offset:160
    s_mov_b64 exec, -1
    s_waitcnt lgkmcnt(12)
    v_mfma_f32_32x32x16_bf16 v[32:47], v[60:63], v[148:151], v[32:47]
    ds_read_b64_tr_b16 v[60:61], v142 offset:12288
    ds_read_b64_tr_b16 v[62:63], v142 offset:12800
    s_mov_b64 exec, s[74:75]
    ds_read_b128 v[60:63], v141 offset:192
    s_mov_b64 exec, -1
    s_waitcnt lgkmcnt(12)
    v_mfma_f32_32x32x16_bf16 v[32:47], v[64:67], v[152:155], v[32:47]
    ds_read_b64_tr_b16 v[64:65], v142 offset:14336
    ds_read_b64_tr_b16 v[66:67], v142 offset:14848
    s_mov_b64 exec, s[74:75]
    ds_read_b128 v[64:67], v141 offset:224
    s_mov_b64 exec, -1
    s_add_u32 m0, s68, 73728
    s_add_u32 s65, s93, 114688
    buffer_load_dwordx4 v4, s[44:47], s65 offen lds
    s_waitcnt lgkmcnt(12)
    v_mfma_f32_32x32x16_bf16 v[32:47], v[48:51], v[156:159], v[32:47]
    ds_read_b64_tr_b16 v[48:49], v142 offset:16384
    ds_read_b64_tr_b16 v[50:51], v142 offset:16896
    s_mov_b64 exec, s[74:75]
    ds_read_b128 v[48:51], v141 offset:256
    s_mov_b64 exec, -1
    s_waitcnt lgkmcnt(12)
    v_mfma_f32_32x32x16_bf16 v[32:47], v[52:55], v[160:163], v[32:47]
    ds_read_b64_tr_b16 v[52:53], v142 offset:18432
    ds_read_b64_tr_b16 v[54:55], v142 offset:18944
    s_mov_b64 exec, s[74:75]
    ds_read_b128 v[52:55], v141 offset:288
    s_mov_b64 exec, -1
    s_waitcnt lgkmcnt(12)
    v_mfma_f32_32x32x16_bf16 v[32:47], v[56:59], v[164:167], v[32:47]
    ds_read_b64_tr_b16 v[56:57], v142 offset:20480
    ds_read_b64_tr_b16 v[58:59], v142 offset:20992
    s_mov_b64 exec, s[74:75]
    ds_read_b128 v[56:59], v141 offset:320
    s_mov_b64 exec, -1
    s_waitcnt lgkmcnt(12)
    v_mfma_f32_32x32x16_bf16 v[32:47], v[60:63], v[168:171], v[32:47]
    ds_read_b64_tr_b16 v[60:61], v142 offset:22528
    ds_read_b64_tr_b16 v[62:63], v142 offset:23040
    s_mov_b64 exec, s[74:75]
    ds_read_b128 v[60:63], v141 offset:352
    s_mov_b64 exec, -1
    s_add_u32 m0, s68, 81920
    s_add_u32 s65, s93, 172032
    buffer_load_dwordx4 v4, s[44:47], s65 offen lds
    s_waitcnt lgkmcnt(12)
    v_mfma_f32_32x32x16_bf16 v[32:47], v[64:67], v[172:175], v[32:47]
    ds_read_b64_tr_b16 v[64:65], v142 offset:24576
    ds_read_b64_tr_b16 v[66:67], v142 offset:25088
    s_mov_b64 exec, s[74:75]
    ds_read_b128 v[64:67], v141 offset:384
    s_mov_b64 exec, -1
    s_waitcnt lgkmcnt(12)
    v_mfma_f32_32x32x16_bf16 v[32:47], v[48:51], v[176:179], v[32:47]
    ds_read_b64_tr_b16 v[48:49], v142 offset:26624
    ds_read_b64_tr_b16 v[50:51], v142 offset:27136
    s_mov_b64 exec, s[74:75]
    ds_read_b128 v[48:51], v141 offset:416
    s_mov_b64 exec, -1
    s_waitcnt lgkmcnt(12)
    v_mfma_f32_32x32x16_bf16 v[32:47], v[52:55], v[180:183], v[32:47]
    ds_read_b64_tr_b16 v[52:53], v142 offset:28672
    ds_read_b64_tr_b16 v[54:55], v142 offset:29184
    s_mov_b64 exec, s[74:75]
    ds_read_b128 v[52:55], v141 offset:448
    s_mov_b64 exec, -1
    s_waitcnt lgkmcnt(12)
    v_mfma_f32_32x32x16_bf16 v[32:47], v[56:59], v[184:187], v[32:47]
    ds_read_b64_tr_b16 v[56:57], v142 offset:30720
    ds_read_b64_tr_b16 v[58:59], v142 offset:31232
    s_mov_b64 exec, s[74:75]
    ds_read_b128 v[56:59], v141 offset:480
    s_mov_b64 exec, -1
    s_add_u32 m0, s68, 90112
    s_add_u32 s65, s93, 229376
    buffer_load_dwordx4 v4, s[44:47], s65 offen lds
    s_waitcnt lgkmcnt(12)
    v_mfma_f32_32x32x16_bf16 v[32:47], v[60:63], v[188:191], v[32:47]
    s_waitcnt lgkmcnt(9)
    v_mfma_f32_32x32x16_bf16 v[32:47], v[64:67], v[192:195], v[32:47]
    s_waitcnt lgkmcnt(6)
    v_mfma_f32_32x32x16_bf16 v[32:47], v[48:51], v[196:199], v[32:47]
    s_waitcnt lgkmcnt(3)
    v_mfma_f32_32x32x16_bf16 v[32:47], v[52:55], v[200:203], v[32:47]
    s_waitcnt lgkmcnt(0)
    v_mfma_f32_32x32x16_bf16 v[32:47], v[56:59], v[204:207], v[32:47]
    s_branch L_q_done
L_c2_hi:
    s_add_u32 s69, s69, 1
    s_add_u32 m0, s68, 106496
    s_nop 0
    buffer_load_dwordx4 v131, s[32:35], s5 offen lds
    s_add_u32 m0, s71, 106496
    s_sub_u32 s65, s5, 86016
    buffer_load_dwordx4 v131, s[32:35], s65 offen lds
    s_add_u32 m0, s68, 114688
    s_nop 0
    buffer_load_dwordx4 v131, s[32:35], s6 offen lds
    s_add_u32 m0, s71, 114688
    s_sub_u32 s65, s6, 86016
    buffer_load_dwordx4 v131, s[32:35], s65 offen lds
    s_add_u32 m0, s68, 122880
    s_nop 0
    buffer_load_dwordx4 v131, s[32:35], s7 offen lds
    s_add_u32 m0, s71, 122880
    s_sub_u32 s65, s7, 86016
    buffer_load_dwordx4 v131, s[32:35], s65 offen lds
    v_lshlrev_b32 v8, 17, v1
    s_and_b32 s65, s56, 3
    s_cmp_eq_u32 s65, 1
    s_cselect_b32 s52, s10, s22
    s_cselect_b32 s53, s11, s23
    s_cmp_eq_u32 s65, 2
    s_cselect_b32 s52, s18, s52
    s_cselect_b32 s53, s19, s53
    s_mov_b32 s54, 401408
    s_mov_b32 s55, 0x00020000
    buffer_load_dword v0, v8, s[52:55], 0 offen
    s_add_u32 m0, s68, 49152
    s_add_u32 s65, s93, 344064
    buffer_load_dwordx4 v4, s[40:43], s65 offen lds
    s_add_u32 m0, s71, 49152
    s_add_u32 s65, s72, 344064
    buffer_load_dwordx4 v4, s[40:43], s65 offen lds
    s_add_u32 m0, s68, 57344
    s_add_u32 s65, s93, 0
    buffer_load_dwordx4 v4, s[44:47], s65 offen lds
    s_add_u32 m0, s71, 57344
    s_add_u32 s65, s72, 0
    buffer_load_dwordx4 v4, s[44:47], s65 offen lds
    s_add_u32 m0, s68, 65536
    s_add_u32 s65, s93, 57344
    buffer_load_dwordx4 v4, s[44:47], s65 offen lds
    s_add_u32 m0, s71, 65536
    s_add_u32 s65, s72, 57344
    buffer_load_dwordx4 v4, s[44:47], s65 offen lds
    s_mov_b32 s74, 0x10000000
    s_mov_b32 s75, 0x10000000
    ds_read_b64_tr_b16 v[48:49], v142 offset:32768
    ds_read_b64_tr_b16 v[50:51], v142 offset:33280
    s_mov_b64 exec, s[74:75]
    ds_read_b128 v[48:51], v141 offset:512
    s_mov_b64 exec, -1
    ds_read_b64_tr_b16 v[52:53], v142 offset:34816
    ds_read_b64_tr_b16 v[54:55], v142 offset:35328
    s_mov_b64 exec, s[74:75]
    ds_read_b128 v[52:55], v141 offset:544
    s_mov_b64 exec, -1
    ds_read_b64_tr_b16 v[56:57], v142 offset:36864
    ds_read_b64_tr_b16 v[58:59], v142 offset:37376
    s_mov_b64 exec, s[74:75]
    ds_read_b128 v[56:59], v141 offset:576
    s_mov_b64 exec, -1
    ds_read_b64_tr_b16 v[60:61], v142 offset:38912
    ds_read_b64_tr_b16 v[62:63], v142 offset:39424
    s_mov_b64 exec, s[74:75]
    ds_read_b128 v[60:63], v141 offset:608
    s_mov_b64 exec, -1
    ds_read_b64_tr_b16 v[64:65], v142 offset:40960
    ds_read_b64_tr_b16 v[66:67], v142 offset:41472
    s_mov_b64 exec, s[74:75]
    ds_read_b128 v[64:67], v141 offset:640
    s_mov_b64 exec, -1
    s_waitcnt lgkmcnt(12)
    v_mfma_f32_32x32x16_bf16 v[32:47], v[48:51], v[208:211], 0
    ds_read_b64_tr_b16 v[48:49], v142 offset:43008
    ds_read_b64_tr_b16 v[50:51], v142 offset:43520
    s_mov_b64 exec, s[74:75]
    ds_read_b128 v[48:51], v141 offset:672
    s_mov_b64 exec, -1
    s_waitcnt lgkmcnt(12)
    v_mfma_f32_32x32x16_bf16 v[32:47], v[52:55], v[212:215], v[32:47]
    ds_read_b64_tr_b16 v[52:53], v142 offset:45056
    ds_read_b64_tr_b16 v[54:55], v142 offset:45568
    s_mov_b64 exec, s[74:75]
    ds_read_b128 v[52:55], v141 offset:704
    s_mov_b64 exec, -1
    s_waitcnt lgkmcnt(12)
    v_mfma_f32_32x32x16_bf16 v[32:47], v[56:59], v[216:219], v[32:47]
    ds_read_b64_tr_b16 v[56:57], v142 offset:47104
    ds_read_b64_tr_b16 v[58:59], v142 offset:47616
    s_mov_b64 exec, s[74:75]
    ds_read_b128 v[56:59], v141 offset:736
    s_mov_b64 exec, -1
    s_waitcnt lgkmcnt(12)
    v_mfma_f32_32x32x16_bf16 v[32:47], v[60:63], v[220:223], v[32:47]
    ds_read_b64_tr_b16 v[60:61], v142 offset:49152
    ds_read_b64_tr_b16 v[62:63], v142 offset:49664
    s_mov_b64 exec, s[74:75]
    ds_read_b128 v[60:63], v141 offset:768
    s_mov_b64 exec, -1
    s_waitcnt lgkmcnt(12)
    v_mfma_f32_32x32x16_bf16 v[32:47], v[64:67], v[224:227], v[32:47]
    ds_read_b64_tr_b16 v[64:65], v142 offset:51200
    ds_read_b64_tr_b16 v[66:67], v142 offset:51712
    s_mov_b64 exec, s[74:75]
    ds_read_b128 v[64:67], v141 offset:800
    s_mov_b64 exec, -1
    s_waitcnt lgkmcnt(12)
    v_mfma_f32_32x32x16_bf16 v[32:47], v[48:51], v[228:231], v[32:47]
    ds_read_b64_tr_b16 v[48:49], v142 offset:53248
    ds_read_b64_tr_b16 v[50:51], v142 offset:53760
    s_mov_b64 exec, s[74:75]
    ds_read_b128 v[48:51], v141 offset:832
    s_mov_b64 exec, -1
    s_waitcnt lgkmcnt(12)
    v_mfma_f32_32x32x16_bf16 v[32:47], v[52:55], v[232:235], v[32:47]
    ds_read_b64_tr_b16 v[52:53], v142 offset:55296
    ds_read_b64_tr_b16 v[54:55], v142 offset:55808
    s_mov_b64 exec, s[74:75]
    ds_read_b128 v[52:55], v141 offset:864
    s_mov_b64 exec, -1
    s_waitcnt lgkmcnt(12)
    v_mfma_f32_32x32x16_bf16 v[32:47], v[56:59], v[236:239], v[32:47]
    ds_read_b64_tr_b16 v[56:57], v142 offset:0
    ds_read_b64_tr_b16 v[58:59], v142 offset:512
    s_mov_b64 exec, s[74:75]
    ds_read_b128 v[56:59], v141 offset:0
    s_mov_b64 exec, -1
    s_waitcnt lgkmcnt(12)
    v_mfma_f32_32x32x16_bf16 v[32:47], v[60:63], v[240:243], v[32:47]
    ds_read_b64_tr_b16 v[60:61], v142 offset:2048
    ds_read_b64_tr_b16 v[62:63], v142 offset:2560
    s_mov_b64 exec, s[74:75]
    ds_read_b128 v[60:63], v141 offset:32
    s_mov_b64 exec, -1
    s_waitcnt lgkmcnt(12)
    v_mfma_f32_32x32x16_bf16 v[32:47], v[64:67], v[244:247], v[32:47]
    ds_read_b64_tr_b16 v[64:65], v142 offset:4096
    ds_read_b64_tr_b16 v[66:67], v142 offset:4608
    s_mov_b64 exec, s[74:75]
    ds_read_b128 v[64:67], v141 offset:64
    s_mov_b64 exec, -1
    s_waitcnt lgkmcnt(12)
    v_mfma_f32_32x32x16_bf16 v[32:47], v[48:51], v[248:251], v[32:47]
    ds_read_b64_tr_b16 v[48:49], v142 offset:6144
    ds_read_b64_tr_b16 v[50:51], v142 offset:6656
    s_mov_b64 exec, s[74:75]
    ds_read_b128 v[48:51], v141 offset:96
    s_mov_b64 exec, -1
    s_waitcnt lgkmcnt(12)
    v_mfma_f32_32x32x16_bf16 v[32:47], v[52:55], v[252:255], v[32:47]
    s_waitcnt vmcnt(7)
    s_barrier
    ds_read_b64_tr_b16 v[52:53], v142 offset:8192
    ds_read_b64_tr_b16 v[54:55], v142 offset:8704
    s_mov_b64 exec, s[74:75]
    ds_read_b128 v[52:55], v141 offset:128
    s_mov_b64 exec, -1
    s_waitcnt lgkmcnt(12)
    v_mfma_f32_32x32x16_bf16 v[32:47], v[56:59], v[144:147], v[32:47]
    ds_read_b64_tr_b16 v[56:57], v142 offset:10240
    ds_read_b64_tr_b16 v[58:59], v142 offset:10752
    s_mov_b64 exec, s[74:75]
    ds_read_b128 v[56:59], v141 offset:160
    s_mov_b64 exec, -1
    s_add_u32 m0, s68, 24576
    s_add_u32 s65, s93, 172032
    buffer_load_dwordx4 v4, s[40:43], s65 offen lds
    s_waitcnt lgkmcnt(12)
    v_mfma_f32_32x32x16_bf16 v[32:47], v[60:63], v[148:151], v[32:47]
    ds_read_b64_tr_b16 v[60:61], v142 offset:12288
    ds_read_b64_tr_b16 v[62:63], v142 offset:12800
    s_mov_b64 exec, s[74:75]
    ds_read_b128 v[60:63], v141 offset:192
    s_mov_b64 exec, -1
    s_waitcnt lgkmcnt(12)
    v_mfma_f32_32x32x16_bf16 v[32:47], v[64:67], v[152:155], v[32:47]
    ds_read_b64_tr_b16 v[64:65], v142 offset:14336
    ds_read_b64_tr_b16 v[66:67], v142 offset:14848
    s_mov_b64 exec, s[74:75]
    ds_read_b128 v[64:67], v141 offset:224
    s_mov_b64 exec, -1
    s_add_u32 m0, s68, 32768
    s_add_u32 s65, s93, 229376
    buffer_load_dwordx4 v4, s[40:43], s65 offen lds
    s_waitcnt lgkmcnt(12)
    v_mfma_f32_32x32x16_bf16 v[32:47], v[48:51], v[156:159], v[32:47]
    ds_read_b64_tr_b16 v[48:49], v142 offset:16384
    ds_read_b64_tr_b16 v[50:51], v142 offset:16896
    s_mov_b64 exec, s[74:75]
    ds_read_b128 v[48:51], v141 offset:256
    s_mov_b64 exec, -1
    s_waitcnt lgkmcnt(12)
    v_mfma_f32_32x32x16_bf16 v[32:47], v[52:55], v[160:163], v[32:47]
    ds_read_b64_tr_b16 v[52:53], v142 offset:18432
    ds_read_b64_tr_b16 v[54:55], v142 offset:18944
    s_mov_b64 exec, s[74:75]
    ds_read_b128 v[52:55], v141 offset:288
    s_mov_b64 exec, -1
    s_waitcnt lgkmcnt(12)
    v_mfma_f32_32x32x16_bf16 v[32:47], v[56:59], v[164:167], v[32:47]
    ds_read_b64_tr_b16 v[56:57], v142 offset:20480
    ds_read_b64_tr_b16 v[58:59], v142 offset:20992
    s_mov_b64 exec, s[74:75]
    ds_read_b128 v[56:59], v141 offset:320
    s_mov_b64 exec, -1
    s_add_u32 m0, s68, 40960
    s_add_u32 s65, s93, 286720
    buffer_load_dwordx4 v4, s[40:43], s65 offen lds
    s_waitcnt lgkmcnt(12)
    v_mfma_f32_32x32x16_bf16 v[32:47], v[60:63], v[168:171], v[32:47]
    ds_read_b64_tr_b16 v[60:61], v142 offset:22528
    ds_read_b64_tr_b16 v[62:63], v142 offset:23040
    s_mov_b64 exec, s[74:75]
    ds_read_b128 v[60:63], v141 offset:352
    s_mov_b64 exec, -1
    s_waitcnt lgkmcnt(12)
    v_mfma_f32_32x32x16_bf16 v[32:47], v[64:67], v[172:175], v[32:47]
    ds_read_b64_tr_b16 v[64:65], v142 offset:24576
    ds_read_b64_tr_b16 v[66:67], v142 offset:25088
    s_mov_b64 exec, s[74:75]
    ds_read_b128 v[64:67], v141 offset:384
    s_mov_b64 exec, -1
    s_add_u32 m0, s68, 73728
    s_add_u32 s65, s93, 114688
    buffer_load_dwordx4 v4, s[44:47], s65 offen lds
    s_waitcnt lgkmcnt(12)
    v_mfma_f32_32x32x16_bf16 v[32:47], v[48:51], v[176:179], v[32:47]
    ds_read_b64_tr_b16 v[48:49], v142 offset:26624
    ds_read_b64_tr_b16 v[50:51], v142 offset:27136
    s_mov_b64 exec, s[74:75]
    ds_read_b128 v[48:51], v141 offset:416
    s_mov_b64 exec, -1
    s_waitcnt lgkmcnt(12)
    v_mfma_f32_32x32x16_bf16 v[32:47], v[52:55], v[180:183], v[32:47]
    ds_read_b64_tr_b16 v[52:53], v142 offset:28672
    ds_read_b64_tr_b16 v[54:55], v142 offset:29184
    s_mov_b64 exec, s[74:75]
    ds_read_b128 v[52:55], v141 offset:448
    s_mov_b64 exec, -1
    s_waitcnt lgkmcnt(12)
    v_mfma_f32_32x32x16_bf16 v[32:47], v[56:59], v[184:187], v[32:47]
    ds_read_b64_tr_b16 v[56:57], v142 offset:30720
    ds_read_b64_tr_b16 v[58:59], v142 offset:31232
    s_mov_b64 exec, s[74:75]
    ds_read_b128 v[56:59], v141 offset:480
    s_mov_b64 exec, -1
    s_add_u32 m0, s68, 81920
    s_add_u32 s65, s93, 172032
    buffer_load_dwordx4 v4, s[44:47], s65 offen lds
    s_waitcnt lgkmcnt(12)
    v_mfma_f32_32x32x16_bf16 v[32:47], v[60:63], v[188:191], v[32:47]
    s_waitcnt lgkmcnt(9)
    v_mfma_f32_32x32x16_bf16 v[32:47], v[64:67], v[192:195], v[32:47]
    s_add_u32 m0, s68, 90112
    s_add_u32 s65, s93, 229376
    buffer_load_dwordx4 v4, s[44:47], s65 offen lds
    s_cmp_lg_u32 s56, 4
    s_cbranch_scc1 L_pi1432
    s_lshl_b32 s96, s60, 11
    s_add_u32 s96, s96, 65536
    v_and_b32 v181, 15, v1
    v_lshlrev_b32 v181, 7, v181
    s_mov_b32 exec_lo, 0xffff
    s_mov_b32 exec_hi, 0
    buffer_load_dword v180, v181, s[36:39], s96 offen sc0 sc1
    s_mov_b64 exec, -1
L_pi1432:
    s_waitcnt lgkmcnt(6)
    v_mfma_f32_32x32x16_bf16 v[32:47], v[48:51], v[196:199], v[32:47]
    s_waitcnt lgkmcnt(3)
    v_mfma_f32_32x32x16_bf16 v[32:47], v[52:55], v[200:203], v[32:47]
    s_waitcnt lgkmcnt(0)
    v_mfma_f32_32x32x16_bf16 v[32:47], v[56:59], v[204:207], v[32:47]
L_q_done:
    s_cmp_lg_u32 s56, 4
    s_cbranch_scc1 L_poll1_done
    s_mov_b32 s83, 0
    s_mov_b32 exec_lo, 0xffff
    s_mov_b32 exec_hi, 0
L_poll1:
    s_waitcnt vmcnt(0)
    v_cmp_ne_u32 vcc, s69, v180
    s_add_u32 s83, s83, 1
    s_cmp_eq_u64 vcc, 0
    s_cbranch_scc1 L_poll1_ok
    buffer_load_dword v180, v181, s[36:39], s96 offen sc0 sc1
    s_cmp_lt_u32 s83, 1000000
    s_cbranch_scc1 L_poll1
L_poll1_ok:
    s_mov_b64 exec, -1
L_poll1_done:
    s_barrier
    s_lshl_b32 s65, s60, 17
    s_lshl_b32 s66, s56, 10
    s_add_u32 s65, s65, s66
    s_add_u32 s65, s65, 1048576
    s_lshl_b32 s66, s57, 13
    s_add_u32 s76, s65, s66
    buffer_load_dwordx4 v[144:147], v14, s[36:39], s76 offen sc0 sc1
    s_add_u32 s66, s66, 8192
    s_and_b32 s66, s66, 0x1ffff
    s_cmp_eq_u32 s58, 0
    s_cselect_b32 s90, 0x80000000, 0
    s_nop 9
    v_mov_b32 v140, v44
    v_mov_b32 v11, v44
    v_cvt_pk_bf16_f32 v88, v32, v33
    v_cvt_pk_bf16_f32 v89, v34, v35
    v_cvt_pk_bf16_f32 v90, v36, v37
    s_add_u32 s76, s65, s66
    buffer_load_dwordx4 v[148:151], v14, s[36:39], s76 offen sc0 sc1
    s_add_u32 s66, s66, 8192
    s_and_b32 s66, s66, 0x1ffff
    v_cvt_pk_bf16_f32 v91, v38, v39
    v_cvt_pk_bf16_f32 v92, v40, v41
    v_cvt_pk_bf16_f32 v93, v42, v43
    v_cvt_pk_bf16_f32 v94, v44, v45
    v_cvt_pk_bf16_f32 v95, v46, v47
    v_permlane32_swap_b32 v140, v11
    s_nop 0
    v_mfma_f32_32x32x16_bf16 v[16:31], v[80:83], v[88:91], 0
    s_add_u32 s76, s65, s66
    buffer_load_dwordx4 v[152:155], v14, s[36:39], s76 offen sc0 sc1
    s_add_u32 s66, s66, 8192
    s_and_b32 s66, s66, 0x1ffff
    v_mfma_f32_32x32x16_bf16 v[16:31], v[84:87], v[92:95], v[16:31]
    v_mul_f32 v140, v3, v11
    v_xor_b32 v140, s90, v140
    v_exp_f32 v140, v140
    s_nop 0
    v_add_f32 v140, 1.0, v140
    v_rcp_f32 v140, v140
    v_mov_b32 v131, 0
    s_add_u32 s76, s65, s66
    buffer_load_dwordx4 v[156:159], v14, s[36:39], s76 offen sc0 sc1
    s_add_u32 s66, s66, 8192
    s_and_b32 s66, s66, 0x1ffff
    v_mov_b32 v139, 0
    s_nop 4
    v_max3_f32 v7, v16, v17, v18
    v_min3_f32 v6, v16, v17, v18
    v_max3_f32 v8, v19, v20, v21
    v_min3_f32 v11, v19, v20, v21
    v_max3_f32 v9, v22, v23, v24
    v_min3_f32 v13, v22, v23, v24
    s_barrier
    s_add_u32 s76, s65, s66
    buffer_load_dwordx4 v[160:163], v14, s[36:39], s76 offen sc0 sc1
    s_add_u32 s66, s66, 8192
    s_and_b32 s66, s66, 0x1ffff
    v_max3_f32 v10, v25, v26, v27
    v_min3_f32 v5, v25, v26, v27
    v_max3_f32 v7, v28, v29, v7
    v_min3_f32 v6, v28, v29, v6
    v_max3_f32 v8, v8, v9, v10
    v_min3_f32 v11, v11, v13, v5
    v_max_f32 v5, v7, v8
    s_add_u32 s76, s65, s66
    buffer_load_dwordx4 v[164:167], v14, s[36:39], s76 offen sc0 sc1
    s_add_u32 s66, s66, 8192
    s_and_b32 s66, s66, 0x1ffff
    v_min_f32 v6, v6, v11
    v_mul_f32_e64 v5, -v3, v5
    v_mul_f32 v6, v3, v6
    s_nop 1
    v_permlane32_swap_b32 v5, v6
    s_nop 1
    v_min_f32 v5, v5, v6
    v_mov_b32 v6, v5
    s_nop 1
    v_permlane32_swap_b32 v5, v6
    s_add_u32 s76, s65, s66
    buffer_load_dwordx4 v[168:171], v14, s[36:39], s76 offen sc0 sc1
    s_add_u32 s66, s66, 8192
    s_and_b32 s66, s66, 0x1ffff
    s_nop 1
    v_fma_f32 v96, v16, v3, v5
    v_fma_f32 v110, v16, -v3, v6
    v_fma_f32 v97, v17, v3, v5
    v_fma_f32 v111, v17, -v3, v6
    v_fma_f32 v98, v18, v3, v5
    v_fma_f32 v112, v18, -v3, v6
    v_fma_f32 v99, v19, v3, v5
    s_add_u32 s76, s65, s66
    buffer_load_dwordx4 v[172:175], v14, s[36:39], s76 offen sc0 sc1
    s_add_u32 s66, s66, 8192
    s_and_b32 s66, s66, 0x1ffff
    v_fma_f32 v113, v19, -v3, v6
    v_fma_f32 v100, v20, v3, v5
    v_fma_f32 v114, v20, -v3, v6
    v_fma_f32 v101, v21, v3, v5
    v_fma_f32 v115, v21, -v3, v6
    v_fma_f32 v102, v22, v3, v5
    v_fma_f32 v116, v22, -v3, v6
    s_barrier
    s_add_u32 s76, s65, s66
    buffer_load_dwordx4 v[176:179], v14, s[36:39], s76 offen sc0 sc1
    s_add_u32 s66, s66, 8192
    s_and_b32 s66, s66, 0x1ffff
    v_fma_f32 v103, v23, v3, v5
    v_fma_f32 v117, v23, -v3, v6
    v_fma_f32 v104, v24, v3, v5
    v_fma_f32 v118, v24, -v3, v6
    v_fma_f32 v105, v25, v3, v5
    v_fma_f32 v119, v25, -v3, v6
    v_fma_f32 v106, v26, v3, v5
    s_add_u32 s76, s65, s66
    buffer_load_dwordx4 v[180:183], v14, s[36:39], s76 offen sc0 sc1
    s_add_u32 s66, s66, 8192
    s_and_b32 s66, s66, 0x1ffff
    v_fma_f32 v120, v26, -v3, v6
    v_fma_f32 v107, v27, v3, v5
    v_fma_f32 v121, v27, -v3, v6
    v_fma_f32 v108, v28, v3, v5
    v_fma_f32 v122, v28, -v3, v6
    v_fma_f32 v109, v29, v3, v5
    v_fma_f32 v123, v29, -v3, v6
    s_add_u32 s76, s65, s66
    buffer_load_dwordx4 v[184:187], v14, s[36:39], s76 offen sc0 sc1
    s_add_u32 s66, s66, 8192
    s_and_b32 s66, s66, 0x1ffff
    v_exp_f32 v96, v96
    v_exp_f32 v97, v97
    v_exp_f32 v98, v98
    v_exp_f32 v99, v99
    v_exp_f32 v100, v100
    v_exp_f32 v101, v101
    v_exp_f32 v102, v102
    s_add_u32 s76, s65, s66
    buffer_load_dwordx4 v[188:191], v14, s[36:39], s76 offen sc0 sc1
    s_add_u32 s66, s66, 8192
    s_and_b32 s66, s66, 0x1ffff
    v_exp_f32 v103, v103
    v_exp_f32 v104, v104
    v_exp_f32 v105, v105
    v_exp_f32 v106, v106
    v_exp_f32 v107, v107
    v_exp_f32 v108, v108
    v_exp_f32 v109, v109
    s_barrier
    s_add_u32 s76, s65, s66
    buffer_load_dwordx4 v[192:195], v14, s[36:39], s76 offen sc0 sc1
    s_add_u32 s66, s66, 8192
    s_and_b32 s66, s66, 0x1ffff
    v_exp_f32 v110, v110
    v_exp_f32 v111, v111
    v_exp_f32 v112, v112
    v_exp_f32 v113, v113
    v_exp_f32 v114, v114
    v_exp_f32 v115, v115
    v_exp_f32 v116, v116
    s_add_u32 s76, s65, s66
    buffer_load_dwordx4 v[196:199], v14, s[36:39], s76 offen sc0 sc1
    s_add_u32 s66, s66, 8192
    s_and_b32 s66, s66, 0x1ffff
    v_exp_f32 v117, v117
    v_exp_f32 v118, v118
    v_exp_f32 v119, v119
    v_exp_f32 v120, v120
    v_exp_f32 v121, v121
    v_exp_f32 v122, v122
    v_exp_f32 v123, v123
    s_add_u32 s76, s65, s66
    buffer_load_dwordx4 v[200:203], v14, s[36:39], s76 offen sc0 sc1
    s_add_u32 s66, s66, 8192
    s_and_b32 s66, s66, 0x1ffff
    v_cvt_pk_bf16_f32 v124, v96, v97
    v_cvt_pk_bf16_f32 v125, v98, v99
    v_cvt_pk_bf16_f32 v126, v100, v101
    v_cvt_pk_bf16_f32 v127, v102, v103
    v_cvt_pk_bf16_f32 v128, v104, v105
    v_cvt_pk_bf16_f32 v129, v106, v107
    v_cvt_pk_bf16_f32 v130, v108, v109
    s_add_u32 s76, s65, s66
    buffer_load_dwordx4 v[204:207], v14, s[36:39], s76 offen sc0 sc1
    v_cvt_pk_bf16_f32 v132, v110, v111
    v_cvt_pk_bf16_f32 v133, v112, v113
    v_cvt_pk_bf16_f32 v134, v114, v115
    v_cvt_pk_bf16_f32 v135, v116, v117
    v_cvt_pk_bf16_f32 v136, v118, v119
    v_cvt_pk_bf16_f32 v137, v120, v121
    v_cvt_pk_bf16_f32 v138, v122, v123
    s_add_u32 m0, s68, 0
    s_add_u32 s65, s93, 0
    buffer_load_dwordx4 v4, s[40:43], s65 offen lds
    s_add_u32 m0, s68, 8192
    s_add_u32 s65, s93, 57344
    buffer_load_dwordx4 v4, s[40:43], s65 offen lds
    s_add_u32 m0, s68, 16384
    s_add_u32 s65, s93, 114688
    buffer_load_dwordx4 v4, s[40:43], s65 offen lds
    s_add_u32 m0, s68, 98304
    s_add_u32 s65, s93, 286720
    buffer_load_dwordx4 v4, s[44:47], s65 offen lds
    s_add_u32 m0, s68, 106496
    s_add_u32 s65, s93, 344064
    buffer_load_dwordx4 v4, s[44:47], s65 offen lds
    v_mov_b32 v16, 0
    v_mov_b32 v17, 0
    v_mov_b32 v18, 0
    v_mov_b32 v19, 0
    v_mov_b32 v20, 0
    v_mov_b32 v21, 0
    v_mov_b32 v22, 0
    v_mov_b32 v23, 0
    s_and_b32 s66, s56, 3
    s_lshl_b32 s77, s57, 2
    s_add_u32 s77, s77, s66
    s_lshl_b32 s77, s77, 1
    s_add_u32 s77, s77, s58
    s_lshl_b32 s77, s77, 4
    s_lshl_b32 s66, s59, 1
    s_add_u32 s77, s77, s66
    s_lshr_b32 s66, s56, 2
    s_add_u32 s77, s77, s66
    s_lshl_b32 s77, s77, 11
    s_add_u32 s77, s77, 3145728
    s_lshl_b32 s78, s57, 4
    s_add_u32 s78, s78, s60
    s_lshl_b32 s78, s78, 7
    s_add_u32 s78, s78, 131072
    s_lshl_b32 s66, s56, 10
    s_add_u32 s66, s66, 131072
    v_add_u32 v7, s66, v14
    s_lshr_b32 s66, s56, 2
    s_lshl_b32 s66, s66, 12
    s_add_u32 s66, s66, 131072
    v_add_u32 v8, s66, v14
    v_mov_b32 v9, 0x358637bd
    v_mov_b32 v10, s69
    s_mov_b32 s74, 0x88000000
    s_mov_b32 s75, 0x88000000
    s_waitcnt vmcnt(20)
    v_dot2c_f32_bf16 v16, s79, v144
    v_dot2c_f32_bf16 v17, s80, v144
    v_dot2c_f32_bf16 v18, s79, v145
    v_dot2c_f32_bf16 v19, s80, v145
    v_dot2c_f32_bf16 v20, s79, v146
    v_dot2c_f32_bf16 v21, s80, v146
    v_dot2c_f32_bf16 v22, s79, v147
    v_dot2c_f32_bf16 v23, s80, v147
    s_waitcnt vmcnt(19)
    v_dot2c_f32_bf16 v16, s79, v148
    v_dot2c_f32_bf16 v17, s80, v148
    v_dot2c_f32_bf16 v18, s79, v149
    v_dot2c_f32_bf16 v19, s80, v149
    v_dot2c_f32_bf16 v20, s79, v150
    v_dot2c_f32_bf16 v21, s80, v150
    v_dot2c_f32_bf16 v22, s79, v151
    v_dot2c_f32_bf16 v23, s80, v151
    s_waitcnt vmcnt(18)
    v_dot2c_f32_bf16 v16, s79, v152
    v_dot2c_f32_bf16 v17, s80, v152
    v_dot2c_f32_bf16 v18, s79, v153
    v_dot2c_f32_bf16 v19, s80, v153
    v_dot2c_f32_bf16 v20, s79, v154
    v_dot2c_f32_bf16 v21, s80, v154
    v_dot2c_f32_bf16 v22, s79, v155
    v_dot2c_f32_bf16 v23, s80, v155
    s_waitcnt vmcnt(17)
    v_dot2c_f32_bf16 v16, s79, v156
    v_dot2c_f32_bf16 v17, s80, v156
    v_dot2c_f32_bf16 v18, s79, v157
    v_dot2c_f32_bf16 v19, s80, v157
    v_dot2c_f32_bf16 v20, s79, v158
    v_dot2c_f32_bf16 v21, s80, v158
    v_dot2c_f32_bf16 v22, s79, v159
    v_dot2c_f32_bf16 v23, s80, v159
    s_waitcnt vmcnt(16)
    v_dot2c_f32_bf16 v16, s79, v160
    v_dot2c_f32_bf16 v17, s80, v160
    v_dot2c_f32_bf16 v18, s79, v161
    v_dot2c_f32_bf16 v19, s80, v161
    v_dot2c_f32_bf16 v20, s79, v162
    v_dot2c_f32_bf16 v21, s80, v162
    v_dot2c_f32_bf16 v22, s79, v163
    v_dot2c_f32_bf16 v23, s80, v163
    s_waitcnt vmcnt(15)
    v_dot2c_f32_bf16 v16, s79, v164
    v_dot2c_f32_bf16 v17, s80, v164
    v_dot2c_f32_bf16 v18, s79, v165
    v_dot2c_f32_bf16 v19, s80, v165
    v_dot2c_f32_bf16 v20, s79, v166
    v_dot2c_f32_bf16 v21, s80, v166
    v_dot2c_f32_bf16 v22, s79, v167
    v_dot2c_f32_bf16 v23, s80, v167
    s_waitcnt vmcnt(14)
    v_dot2c_f32_bf16 v16, s79, v168
    v_dot2c_f32_bf16 v17, s80, v168
    v_dot2c_f32_bf16 v18, s79, v169
    v_dot2c_f32_bf16 v19, s80, v169
    v_dot2c_f32_bf16 v20, s79, v170
    v_dot2c_f32_bf16 v21, s80, v170
    v_dot2c_f32_bf16 v22, s79, v171
    v_dot2c_f32_bf16 v23, s80, v171
    s_waitcnt vmcnt(13)
    v_dot2c_f32_bf16 v16, s79, v172
    v_dot2c_f32_bf16 v17, s80, v172
    v_dot2c_f32_bf16 v18, s79, v173
    v_dot2c_f32_bf16 v19, s80, v173
    v_dot2c_f32_bf16 v20, s79, v174
    v_dot2c_f32_bf16 v21, s80, v174
    v_dot2c_f32_bf16 v22, s79, v175
    v_dot2c_f32_bf16 v23, s80, v175
    s_waitcnt vmcnt(12)
    v_dot2c_f32_bf16 v16, s79, v176
    v_dot2c_f32_bf16 v17, s80, v176
    v_dot2c_f32_bf16 v18, s79, v177
    v_dot2c_f32_bf16 v19, s80, v177
    v_dot2c_f32_bf16 v20, s79, v178
    v_dot2c_f32_bf16 v21, s80, v178
    v_dot2c_f32_bf16 v22, s79, v179
    v_dot2c_f32_bf16 v23, s80, v179
    s_waitcnt vmcnt(11)
    v_dot2c_f32_bf16 v16, s79, v180
    v_dot2c_f32_bf16 v17, s80, v180
    v_dot2c_f32_bf16 v18, s79, v181
    v_dot2c_f32_bf16 v19, s80, v181
    v_dot2c_f32_bf16 v20, s79, v182
    v_dot2c_f32_bf16 v21, s80, v182
    v_dot2c_f32_bf16 v22, s79, v183
    v_dot2c_f32_bf16 v23, s80, v183
    s_waitcnt vmcnt(10)
    v_dot2c_f32_bf16 v16, s79, v184
    v_dot2c_f32_bf16 v17, s80, v184
    v_dot2c_f32_bf16 v18, s79, v185
    v_dot2c_f32_bf16 v19, s80, v185
    v_dot2c_f32_bf16 v20, s79, v186
    v_dot2c_f32_bf16 v21, s80, v186
    v_dot2c_f32_bf16 v22, s79, v187
    v_dot2c_f32_bf16 v23, s80, v187
    s_waitcnt vmcnt(9)
    v_dot2c_f32_bf16 v16, s79, v188
    v_dot2c_f32_bf16 v17, s80, v188
    v_dot2c_f32_bf16 v18, s79, v189
    v_dot2c_f32_bf16 v19, s80, v189
    v_dot2c_f32_bf16 v20, s79, v190
    v_dot2c_f32_bf16 v21, s80, v190
    v_dot2c_f32_bf16 v22, s79, v191
    v_dot2c_f32_bf16 v23, s80, v191
    s_waitcnt vmcnt(8)
    v_dot2c_f32_bf16 v16, s79, v192
    v_dot2c_f32_bf16 v17, s80, v192
    v_dot2c_f32_bf16 v18, s79, v193
    v_dot2c_f32_bf16 v19, s80, v193
    v_dot2c_f32_bf16 v20, s79, v194
    v_dot2c_f32_bf16 v21, s80, v194
    v_dot2c_f32_bf16 v22, s79, v195
    v_dot2c_f32_bf16 v23, s80, v195
    s_waitcnt vmcnt(7)
    v_dot2c_f32_bf16 v16, s79, v196
    v_dot2c_f32_bf16 v17, s80, v196
    v_dot2c_f32_bf16 v18, s79, v197
    v_dot2c_f32_bf16 v19, s80, v197
    v_dot2c_f32_bf16 v20, s79, v198
    v_dot2c_f32_bf16 v21, s80, v198
    v_dot2c_f32_bf16 v22, s79, v199
    v_dot2c_f32_bf16 v23, s80, v199
    s_waitcnt vmcnt(6)
    v_dot2c_f32_bf16 v16, s79, v200
    v_dot2c_f32_bf16 v17, s80, v200
    v_dot2c_f32_bf16 v18, s79, v201
    v_dot2c_f32_bf16 v19, s80, v201
    v_dot2c_f32_bf16 v20, s79, v202
    v_dot2c_f32_bf16 v21, s80, v202
    v_dot2c_f32_bf16 v22, s79, v203
    v_dot2c_f32_bf16 v23, s80, v203
    s_waitcnt vmcnt(5)
    v_dot2c_f32_bf16 v16, s79, v204
    v_dot2c_f32_bf16 v17, s80, v204
    v_dot2c_f32_bf16 v18, s79, v205
    v_dot2c_f32_bf16 v19, s80, v205
    v_dot2c_f32_bf16 v20, s79, v206
    v_dot2c_f32_bf16 v21, s80, v206
    v_dot2c_f32_bf16 v22, s79, v207
    v_dot2c_f32_bf16 v23, s80, v207
    s_nop 1
    v_cvt_pk_bf16_f32 v24, v16, v17
    v_cvt_pk_bf16_f32 v25, v18, v19
    v_cvt_pk_bf16_f32 v26, v20, v21
    v_cvt_pk_bf16_f32 v27, v22, v23
    s_mov_b64 exec, s[74:75]
    v_mov_b32 v24, 0x3f803f80
    v_mov_b32 v25, 0x3f803f80
    v_mov_b32 v26, 0x3f803f80
    v_mov_b32 v27, 0x3f803f80
    s_mov_b64 exec, -1
    ds_write_b128 v7, v[24:27]
    s_waitcnt lgkmcnt(0)
    s_barrier
    ds_read_b128 v[48:51], v8 offset:0
    ds_read_b128 v[56:59], v8 offset:2048
    ds_read_b128 v[52:55], v8 offset:1024
    ds_read_b128 v[60:63], v8 offset:3072
    s_waitcnt lgkmcnt(3)
    v_mfma_f32_32x32x16_bf16 v[16:31], v[48:51], v[124:127], 0
    s_waitcnt lgkmcnt(2)
    v_mfma_f32_32x32x16_bf16 v[32:47], v[56:59], v[132:135], 0
    s_waitcnt lgkmcnt(1)
    v_mfma_f32_32x32x16_bf16 v[16:31], v[52:55], v[128:131], v[16:31]
    s_waitcnt lgkmcnt(0)
    v_mfma_f32_32x32x16_bf16 v[32:47], v[60:63], v[136:139], v[32:47]
    v_mov_b32 v95, 0
    v_mov_b32 v13, 0
    s_nop 9
    v_mul_f32 v6, v30, v47
    v_mul_f32 v7, v31, v47
    v_fmac_f32 v6, v46, v31
    v_fmac_f32 v6, v7, v9
    v_rcp_f32 v6, v6
    s_nop 0
    v_mul_f32 v6, v6, v140
    v_mul_f32 v7, v47, v6
    v_mul_f32 v8, v31, v6
    v_mul_f32 v16, v16, v7
    v_mul_f32 v17, v17, v7
    v_fmac_f32 v16, v32, v8
    v_fmac_f32 v17, v33, v8
    v_cvt_pk_bf16_f32 v88, v16, v17
    v_mul_f32 v18, v18, v7
    v_mul_f32 v19, v19, v7
    v_fmac_f32 v18, v34, v8
    v_fmac_f32 v19, v35, v8
    v_cvt_pk_bf16_f32 v89, v18, v19
    v_mul_f32 v20, v20, v7
    v_mul_f32 v21, v21, v7
    v_fmac_f32 v20, v36, v8
    v_fmac_f32 v21, v37, v8
    v_cvt_pk_bf16_f32 v90, v20, v21
    v_mul_f32 v22, v22, v7
    v_mul_f32 v23, v23, v7
    v_fmac_f32 v22, v38, v8
    v_fmac_f32 v23, v39, v8
    v_cvt_pk_bf16_f32 v91, v22, v23
    buffer_store_dwordx4 v[88:91], v14, s[36:39], s77 offen sc0 sc1
    v_mul_f32 v24, v24, v7
    v_mul_f32 v25, v25, v7
    v_fmac_f32 v24, v40, v8
    v_fmac_f32 v25, v41, v8
    v_cvt_pk_bf16_f32 v92, v24, v25
    v_mul_f32 v26, v26, v7
    v_mul_f32 v27, v27, v7
    v_fmac_f32 v26, v42, v8
    v_fmac_f32 v27, v43, v8
    v_cvt_pk_bf16_f32 v93, v26, v27
    v_mul_f32 v28, v28, v7
    v_mul_f32 v29, v29, v7
    v_fmac_f32 v28, v44, v8
    v_fmac_f32 v29, v45, v8
    v_cvt_pk_bf16_f32 v94, v28, v29
    buffer_store_dwordx4 v[92:95], v14, s[36:39], s77 offen offset:1024 sc0 sc1
    s_waitcnt vmcnt(0)
    s_barrier
    s_cmp_lg_u32 s56, 1
    s_cbranch_scc1 L_noflag2
    s_mov_b64 exec, 1
    buffer_store_dword v10, v13, s[36:39], s78 offen sc0 sc1
    s_mov_b64 exec, -1
L_noflag2:
    s_cmp_ge_u32 s70, 28
    s_cbranch_scc1 L_fin
    v_lshrrev_b32 v5, 5, v1
    v_and_b32 v6, 15, v1
    v_lshrrev_b32 v7, 2, v6
    v_and_b32 v6, 3, v6
    v_lshlrev_b32 v6, 3, v6
    v_and_b32 v8, 16, v1
    v_lshl_add_u32 v6, v8, 1, v6
    s_lshr_b32 s66, s56, 2
    s_mul_i32 s65, s66, 448
    s_lshr_b32 s66, s56, 1
    s_and_b32 s66, s66, 1
    s_mul_i32 s66, s66, 224
    s_add_u32 s65, s65, s66
    s_mul_i32 s66, s88, 28
    s_add_u32 s65, s65, s66
    s_lshl_b32 s65, s65, 7
    v_lshl_add_u32 v8, v5, 2, v7
    v_lshlrev_b32 v8, 7, v8
    v_and_b32 v9, 2, v7
    v_lshlrev_b32 v9, 5, v9
    v_xor_b32 v10, v6, v9
    v_add_u32 v8, v8, v10
    v_add_u32 v176, s65, v8
    v_xor_b32 v177, 64, v176
    v_lshl_add_u32 v8, v5, 1, v7
    v_add_u32 v10, 24, v8
    v_add_u32 v8, 20, v8
    v_cmp_gt_u32 vcc, 2, v7
    v_lshlrev_b32 v5, 6, v5
    v_xor_b32 v9, v9, v5
    v_cndmask_b32 v8, v8, v10, vcc
    v_lshlrev_b32 v8, 7, v8
    v_xor_b32 v10, v6, v9
    v_add_u32 v8, v8, v10
    v_add_u32 v178, s65, v8
    v_xor_b32 v179, 64, v178
    s_cmp_eq_u32 s56, 0
    ds_read_b64_tr_b16 v[48:49], v176 offset:0
    ds_read_b64_tr_b16 v[50:51], v176 offset:1024
    ds_read_b64_tr_b16 v[52:53], v177 offset:0
    ds_read_b64_tr_b16 v[54:55], v177 offset:1024
    ds_read_b64_tr_b16 v[56:57], v176 offset:2048
    ds_read_b64_tr_b16 v[58:59], v178 offset:0
    ds_read_b64_tr_b16 v[60:61], v177 offset:2048
    ds_read_b64_tr_b16 v[62:63], v179 offset:0
    ds_read_b64_tr_b16 v[64:65], v176 offset:3584
    ds_read_b64_tr_b16 v[66:67], v176 offset:4608
    ds_read_b64_tr_b16 v[68:69], v177 offset:3584
    ds_read_b64_tr_b16 v[70:71], v177 offset:4608
    ds_read_b64_tr_b16 v[72:73], v176 offset:5632
    ds_read_b64_tr_b16 v[74:75], v178 offset:3584
    ds_read_b64_tr_b16 v[76:77], v177 offset:5632
    ds_read_b64_tr_b16 v[78:79], v179 offset:3584
    s_cmp_eq_u32 s88, 6
    s_cbranch_scc0 L_nowrap2
    v_subrev_u32 v176, 28672, v176
    v_subrev_u32 v177, 28672, v177
    v_subrev_u32 v178, 28672, v178
    v_subrev_u32 v179, 28672, v179
L_nowrap2:
    ds_read_b64_tr_b16 v[80:81], v176 offset:7168
    ds_read_b64_tr_b16 v[82:83], v176 offset:8192
    ds_read_b64_tr_b16 v[84:85], v177 offset:7168
    ds_read_b64_tr_b16 v[86:87], v177 offset:8192
    ds_read_b64_tr_b16 v[88:89], v176 offset:9216
    ds_read_b64_tr_b16 v[90:91], v178 offset:7168
    ds_read_b64_tr_b16 v[92:93], v177 offset:9216
    ds_read_b64_tr_b16 v[94:95], v179 offset:7168
    s_cmp_eq_u32 s88, 5
    s_cbranch_scc0 L_nowrap3
    v_subrev_u32 v176, 28672, v176
    v_subrev_u32 v177, 28672, v177
    v_subrev_u32 v178, 28672, v178
    v_subrev_u32 v179, 28672, v179
L_nowrap3:
    ds_read_b64_tr_b16 v[96:97], v176 offset:10752
    ds_read_b64_tr_b16 v[98:99], v176 offset:11776
    ds_read_b64_tr_b16 v[100:101], v177 offset:10752
    ds_read_b64_tr_b16 v[102:103], v177 offset:11776
    ds_read_b64_tr_b16 v[104:105], v176 offset:12800
    ds_read_b64_tr_b16 v[106:107], v178 offset:10752
    ds_read_b64_tr_b16 v[108:109], v177 offset:12800
    ds_read_b64_tr_b16 v[110:111], v179 offset:10752
    s_cmp_eq_u32 s88, 4
    s_cbranch_scc0 L_nowrap4
    v_subrev_u32 v176, 28672, v176
    v_subrev_u32 v177, 28672, v177
    v_subrev_u32 v178, 28672, v178
    v_subrev_u32 v179, 28672, v179
L_nowrap4:
    ds_read_b64_tr_b16 v[112:113], v176 offset:14336
    ds_read_b64_tr_b16 v[114:115], v176 offset:15360
    ds_read_b64_tr_b16 v[116:117], v177 offset:14336
    ds_read_b64_tr_b16 v[118:119], v177 offset:15360
    s_cmp_lg_u32 s56, 0
    s_cbranch_scc1 L_pi2034
    s_lshr_b32 s96, s81, 1
    s_lshl_b32 s96, s96, 11
    s_add_u32 s96, s96, 131072
    v_and_b32 v181, 15, v1
    v_lshlrev_b32 v181, 7, v181
    s_mov_b32 exec_lo, 0xffff
    s_mov_b32 exec_hi, 0
    buffer_load_dword v180, v181, s[36:39], s96 offen sc0 sc1
    s_mov_b64 exec, -1
L_pi2034:
    ds_read_b64_tr_b16 v[120:121], v176 offset:16384
    ds_read_b64_tr_b16 v[122:123], v178 offset:14336
    ds_read_b64_tr_b16 v[124:125], v177 offset:16384
    ds_read_b64_tr_b16 v[126:127], v179 offset:14336
    s_cmp_eq_u32 s88, 3
    s_cbranch_scc0 L_nowrap5
    v_subrev_u32 v176, 28672, v176
    v_subrev_u32 v177, 28672, v177
    v_subrev_u32 v178, 28672, v178
    v_subrev_u32 v179, 28672, v179
L_nowrap5:
    ds_read_b64_tr_b16 v[128:129], v176 offset:17920
    ds_read_b64_tr_b16 v[130:131], v176 offset:18944
    ds_read_b64_tr_b16 v[132:133], v177 offset:17920
    ds_read_b64_tr_b16 v[134:135], v177 offset:18944
    ds_read_b64_tr_b16 v[136:137], v176 offset:19968
    ds_read_b64_tr_b16 v[138:139], v178 offset:17920
    ds_read_b64_tr_b16 v[140:141], v177 offset:19968
    ds_read_b64_tr_b16 v[142:143], v179 offset:17920
    s_cmp_eq_u32 s88, 2
    s_cbranch_scc0 L_nowrap6
    v_subrev_u32 v176, 28672, v176
    v_subrev_u32 v177, 28672, v177
    v_subrev_u32 v178, 28672, v178
    v_subrev_u32 v179, 28672, v179
L_nowrap6:
    ds_read_b64_tr_b16 v[144:145], v176 offset:21504
    ds_read_b64_tr_b16 v[146:147], v176 offset:22528
    ds_read_b64_tr_b16 v[148:149], v177 offset:21504
    ds_read_b64_tr_b16 v[150:151], v177 offset:22528
    ds_read_b64_tr_b16 v[152:153], v176 offset:23552
    ds_read_b64_tr_b16 v[154:155], v178 offset:21504
    ds_read_b64_tr_b16 v[156:157], v177 offset:23552
    ds_read_b64_tr_b16 v[158:159], v179 offset:21504
    s_cmp_eq_u32 s88, 1
    s_cbranch_scc0 L_nowrap7
    v_subrev_u32 v176, 28672, v176
    v_subrev_u32 v177, 28672, v177
    v_subrev_u32 v178, 28672, v178
    v_subrev_u32 v179, 28672, v179
L_nowrap7:
    ds_read_b64_tr_b16 v[160:161], v176 offset:25088
    ds_read_b64_tr_b16 v[162:163], v176 offset:26112
    ds_read_b64_tr_b16 v[164:165], v177 offset:25088
    ds_read_b64_tr_b16 v[166:167], v177 offset:26112
    ds_read_b64_tr_b16 v[168:169], v176 offset:27136
    ds_read_b64_tr_b16 v[170:171], v178 offset:25088
    ds_read_b64_tr_b16 v[172:173], v177 offset:27136
    ds_read_b64_tr_b16 v[174:175], v179 offset:25088
    s_lshl_b32 s76, s81, 1
    s_and_b32 s66, s56, 1
    s_add_u32 s76, s76, s66
    s_lshl_b32 s76, s76, 1
    s_lshr_b32 s66, s56, 2
    s_add_u32 s76, s76, s66
    s_lshl_b32 s76, s76, 15
    s_lshr_b32 s66, s56, 1
    s_and_b32 s66, s66, 1
    s_lshl_b32 s66, s66, 14
    s_add_u32 s76, s76, s66
    s_add_u32 s76, s76, 3145728
    s_and_b32 s66, s56, 1
    s_lshl_b32 s66, s66, 15
    s_lshr_b32 s78, s56, 1
    s_lshl_b32 s77, s78, 11
    s_add_u32 s77, s77, s66
    v_add_u32 v7, s77, v14
    s_lshl_b32 s77, s78, 13
    s_add_u32 s77, s77, s66
    v_add_u32 v9, s77, v14
    s_lshl_b32 s77, s81, 1
    s_and_b32 s66, s56, 1
    s_add_u32 s77, s77, s66
    s_mul_i32 s77, s77, 28672
    s_add_u32 s77, s77, s82
    s_lshl_b32 s66, s78, 5
    s_add_u32 s77, s77, s66
    v_and_b32 v8, 31, v1
    v_mul_u32_u24 v8, 896, v8
    v_lshrrev_b32 v10, 5, v1
    v_lshl_add_u32 v8, v10, 4, v8
    s_cmp_lg_u32 s56, 0
    s_cbranch_scc1 L_poll2_done
    s_mov_b32 s83, 0
    s_mov_b32 exec_lo, 0xffff
    s_mov_b32 exec_hi, 0
L_poll2:
    s_waitcnt vmcnt(0)
    v_cmp_ne_u32 vcc, s69, v180
    s_add_u32 s83, s83, 1
    s_cmp_eq_u64 vcc, 0
    s_cbranch_scc1 L_poll2_ok
    buffer_load_dword v180, v181, s[36:39], s96 offen sc0 sc1
    s_cmp_lt_u32 s83, 1000000
    s_cbranch_scc1 L_poll2
L_poll2_ok:
    s_mov_b64 exec, -1
L_poll2_done:
    s_waitcnt lgkmcnt(0)
    s_barrier
    s_lshl_b32 s66, s88, 11
    s_add_u32 s65, s76, s66
    buffer_load_dwordx4 v[192:195], v14, s[36:39], s65 offen sc0 sc1
    s_add_u32 s66, s66, 1024
    s_and_b32 s66, s66, 0x3fff
    s_add_u32 s65, s76, s66
    buffer_load_dwordx4 v[196:199], v14, s[36:39], s65 offen sc0 sc1
    s_add_u32 s66, s66, 1024
    s_and_b32 s66, s66, 0x3fff
    s_add_u32 s65, s76, s66
    buffer_load_dwordx4 v[200:203], v14, s[36:39], s65 offen sc0 sc1
    s_add_u32 s66, s66, 1024
    s_and_b32 s66, s66, 0x3fff
    s_add_u32 s65, s76, s66
    buffer_load_dwordx4 v[204:207], v14, s[36:39], s65 offen sc0 sc1
    s_add_u32 s66, s66, 1024
    s_and_b32 s66, s66, 0x3fff
    s_add_u32 s65, s76, s66
    buffer_load_dwordx4 v[208:211], v14, s[36:39], s65 offen sc0 sc1
    s_add_u32 s66, s66, 1024
    s_and_b32 s66, s66, 0x3fff
    s_add_u32 s65, s76, s66
    buffer_load_dwordx4 v[212:215], v14, s[36:39], s65 offen sc0 sc1
    s_add_u32 s66, s66, 1024
    s_and_b32 s66, s66, 0x3fff
    s_add_u32 s65, s76, s66
    buffer_load_dwordx4 v[216:219], v14, s[36:39], s65 offen sc0 sc1
    s_add_u32 s66, s66, 1024
    s_and_b32 s66, s66, 0x3fff
    s_add_u32 s65, s76, s66
    buffer_load_dwordx4 v[220:223], v14, s[36:39], s65 offen sc0 sc1
    s_add_u32 s66, s66, 1024
    s_and_b32 s66, s66, 0x3fff
    s_add_u32 s65, s76, s66
    buffer_load_dwordx4 v[224:227], v14, s[36:39], s65 offen sc0 sc1
    s_add_u32 s66, s66, 1024
    s_and_b32 s66, s66, 0x3fff
    s_add_u32 s65, s76, s66
    buffer_load_dwordx4 v[228:231], v14, s[36:39], s65 offen sc0 sc1
    s_add_u32 s66, s66, 1024
    s_and_b32 s66, s66, 0x3fff
    s_add_u32 s65, s76, s66
    buffer_load_dwordx4 v[232:235], v14, s[36:39], s65 offen sc0 sc1
    s_add_u32 s66, s66, 1024
    s_and_b32 s66, s66, 0x3fff
    s_add_u32 s65, s76, s66
    buffer_load_dwordx4 v[236:239], v14, s[36:39], s65 offen sc0 sc1
    s_add_u32 s66, s66, 1024
    s_and_b32 s66, s66, 0x3fff
    s_add_u32 s65, s76, s66
    buffer_load_dwordx4 v[240:243], v14, s[36:39], s65 offen sc0 sc1
    s_add_u32 s66, s66, 1024
    s_and_b32 s66, s66, 0x3fff
    s_add_u32 s65, s76, s66
    buffer_load_dwordx4 v[244:247], v14, s[36:39], s65 offen sc0 sc1
    s_add_u32 s66, s66, 1024
    s_and_b32 s66, s66, 0x3fff
    s_add_u32 s65, s76, s66
    buffer_load_dwordx4 v[248:251], v14, s[36:39], s65 offen sc0 sc1
    s_add_u32 s66, s66, 1024
    s_and_b32 s66, s66, 0x3fff
    s_add_u32 s65, s76, s66
    buffer_load_dwordx4 v[252:255], v14, s[36:39], s65 offen sc0 sc1
    s_waitcnt vmcnt(15)
    v_mfma_f32_32x32x16_bf16 v[16:31], v[48:51], v[192:195], 0
    v_mfma_f32_32x32x16_bf16 v[32:47], v[52:55], v[192:195], 0
    s_waitcnt vmcnt(14)
    v_mfma_f32_32x32x16_bf16 v[16:31], v[56:59], v[196:199], v[16:31]
    v_mfma_f32_32x32x16_bf16 v[32:47], v[60:63], v[196:199], v[32:47]
    s_waitcnt vmcnt(13)
    v_mfma_f32_32x32x16_bf16 v[16:31], v[64:67], v[200:203], v[16:31]
    v_mfma_f32_32x32x16_bf16 v[32:47], v[68:71], v[200:203], v[32:47]
    s_waitcnt vmcnt(12)
    v_mfma_f32_32x32x16_bf16 v[16:31], v[72:75], v[204:207], v[16:31]
    v_mfma_f32_32x32x16_bf16 v[32:47], v[76:79], v[204:207], v[32:47]
    s_waitcnt vmcnt(11)
    v_mfma_f32_32x32x16_bf16 v[16:31], v[80:83], v[208:211], v[16:31]
    v_mfma_f32_32x32x16_bf16 v[32:47], v[84:87], v[208:211], v[32:47]
    s_waitcnt vmcnt(10)
    v_mfma_f32_32x32x16_bf16 v[16:31], v[88:91], v[212:215], v[16:31]
    v_mfma_f32_32x32x16_bf16 v[32:47], v[92:95], v[212:215], v[32:47]
    s_waitcnt vmcnt(9)
    v_mfma_f32_32x32x16_bf16 v[16:31], v[96:99], v[216:219], v[16:31]
    v_mfma_f32_32x32x16_bf16 v[32:47], v[100:103], v[216:219], v[32:47]
    s_waitcnt vmcnt(8)
    v_mfma_f32_32x32x16_bf16 v[16:31], v[104:107], v[220:223], v[16:31]
    v_mfma_f32_32x32x16_bf16 v[32:47], v[108:111], v[220:223], v[32:47]
    s_waitcnt vmcnt(7)
    v_mfma_f32_32x32x16_bf16 v[16:31], v[112:115], v[224:227], v[16:31]
    v_mfma_f32_32x32x16_bf16 v[32:47], v[116:119], v[224:227], v[32:47]
    s_waitcnt vmcnt(6)
    v_mfma_f32_32x32x16_bf16 v[16:31], v[120:123], v[228:231], v[16:31]
    v_mfma_f32_32x32x16_bf16 v[32:47], v[124:127], v[228:231], v[32:47]
    s_waitcnt vmcnt(5)
    v_mfma_f32_32x32x16_bf16 v[16:31], v[128:131], v[232:235], v[16:31]
    v_mfma_f32_32x32x16_bf16 v[32:47], v[132:135], v[232:235], v[32:47]
    s_waitcnt vmcnt(4)
    v_mfma_f32_32x32x16_bf16 v[16:31], v[136:139], v[236:239], v[16:31]
    v_mfma_f32_32x32x16_bf16 v[32:47], v[140:143], v[236:239], v[32:47]
    s_waitcnt vmcnt(3)
    v_mfma_f32_32x32x16_bf16 v[16:31], v[144:147], v[240:243], v[16:31]
    v_mfma_f32_32x32x16_bf16 v[32:47], v[148:151], v[240:243], v[32:47]
    s_waitcnt vmcnt(2)
    v_mfma_f32_32x32x16_bf16 v[16:31], v[152:155], v[244:247], v[16:31]
    v_mfma_f32_32x32x16_bf16 v[32:47], v[156:159], v[244:247], v[32:47]
    s_waitcnt vmcnt(1)
    v_mfma_f32_32x32x16_bf16 v[16:31], v[160:163], v[248:251], v[16:31]
    v_mfma_f32_32x32x16_bf16 v[32:47], v[164:167], v[248:251], v[32:47]
    s_waitcnt vmcnt(0)
    v_mfma_f32_32x32x16_bf16 v[16:31], v[168:171], v[252:255], v[16:31]
    v_mfma_f32_32x32x16_bf16 v[32:47], v[172:175], v[252:255], v[32:47]
    s_cmp_eq_u32 s78, 0
    s_cbranch_scc1 L_rs0
    s_cmp_eq_u32 s78, 1
    s_cbranch_scc1 L_rs1
    s_cmp_eq_u32 s78, 2
    s_cbranch_scc1 L_rs2
    s_nop 9
    ds_write_b128 v7, v[16:19] offset:0
    ds_write_b128 v7, v[20:23] offset:1024
    ds_write_b128 v7, v[24:27] offset:8192
    ds_write_b128 v7, v[28:31] offset:9216
    ds_write_b128 v7, v[32:35] offset:16384
    ds_write_b128 v7, v[36:39] offset:17408
    s_waitcnt lgkmcnt(0)
    v_mov_b32 v16, v40
    v_mov_b32 v17, v41
    v_mov_b32 v18, v42
    v_mov_b32 v19, v43
    v_mov_b32 v20, v44
    v_mov_b32 v21, v45
    v_mov_b32 v22, v46
    v_mov_b32 v23, v47
    s_barrier
    ds_read_b128 v[48:51], v9 offset:0
    ds_read_b128 v[52:55], v9 offset:1024
    ds_read_b128 v[56:59], v9 offset:2048
    ds_read_b128 v[60:63], v9 offset:3072
    ds_read_b128 v[64:67], v9 offset:4096
    ds_read_b128 v[68:71], v9 offset:5120
    s_branch L_rsdone
L_rs0:
    s_nop 9
    ds_write_b128 v7, v[24:27] offset:8192
    ds_write_b128 v7, v[28:31] offset:9216
    ds_write_b128 v7, v[32:35] offset:16384
    ds_write_b128 v7, v[36:39] offset:17408
    ds_write_b128 v7, v[40:43] offset:24576
    ds_write_b128 v7, v[44:47] offset:25600
    s_waitcnt lgkmcnt(0)
    s_barrier
    ds_read_b128 v[48:51], v9 offset:2048
    ds_read_b128 v[52:55], v9 offset:3072
    ds_read_b128 v[56:59], v9 offset:4096
    ds_read_b128 v[60:63], v9 offset:5120
    ds_read_b128 v[64:67], v9 offset:6144
    ds_read_b128 v[68:71], v9 offset:7168
    s_branch L_rsdone
L_rs1:
    s_nop 9
    ds_write_b128 v7, v[16:19] offset:0
    ds_write_b128 v7, v[20:23] offset:1024
    ds_write_b128 v7, v[32:35] offset:16384
    ds_write_b128 v7, v[36:39] offset:17408
    ds_write_b128 v7, v[40:43] offset:24576
    ds_write_b128 v7, v[44:47] offset:25600
    s_waitcnt lgkmcnt(0)
    v_mov_b32 v16, v24
    v_mov_b32 v17, v25
    v_mov_b32 v18, v26
    v_mov_b32 v19, v27
    v_mov_b32 v20, v28
    v_mov_b32 v21, v29
    v_mov_b32 v22, v30
    v_mov_b32 v23, v31
    s_barrier
    ds_read_b128 v[48:51], v9 offset:0
    ds_read_b128 v[52:55], v9 offset:1024
    ds_read_b128 v[56:59], v9 offset:4096
    ds_read_b128 v[60:63], v9 offset:5120
    ds_read_b128 v[64:67], v9 offset:6144
    ds_read_b128 v[68:71], v9 offset:7168
    s_branch L_rsdone
L_rs2:
    s_nop 9
    ds_write_b128 v7, v[16:19] offset:0
    ds_write_b128 v7, v[20:23] offset:1024
    ds_write_b128 v7, v[24:27] offset:8192
    ds_write_b128 v7, v[28:31] offset:9216
    ds_write_b128 v7, v[40:43] offset:24576
    ds_write_b128 v7, v[44:47] offset:25600
    s_waitcnt lgkmcnt(0)
    v_mov_b32 v16, v32
    v_mov_b32 v17, v33
    v_mov_b32 v18, v34
    v_mov_b32 v19, v35
    v_mov_b32 v20, v36
    v_mov_b32 v21, v37
    v_mov_b32 v22, v38
    v_mov_b32 v23, v39
    s_barrier
    ds_read_b128 v[48:51], v9 offset:0
    ds_read_b128 v[52:55], v9 offset:1024
    ds_read_b128 v[56:59], v9 offset:2048
    ds_read_b128 v[60:63], v9 offset:3072
    ds_read_b128 v[64:67], v9 offset:6144
    ds_read_b128 v[68:71], v9 offset:7168
L_rsdone:
    s_waitcnt lgkmcnt(4)
    v_add_f32 v16, v16, v48
    v_add_f32 v17, v17, v49
    v_add_f32 v18, v18, v50
    v_add_f32 v19, v19, v51
    v_add_f32 v20, v20, v52
    v_add_f32 v21, v21, v53
    v_add_f32 v22, v22, v54
    v_add_f32 v23, v23, v55
    s_waitcnt lgkmcnt(2)
    v_add_f32 v16, v16, v56
    v_add_f32 v17, v17, v57
    v_add_f32 v18, v18, v58
    v_add_f32 v19, v19, v59
    v_add_f32 v20, v20, v60
    v_add_f32 v21, v21, v61
    v_add_f32 v22, v22, v62
    v_add_f32 v23, v23, v63
    s_waitcnt lgkmcnt(0)
    v_add_f32 v16, v16, v64
    v_add_f32 v17, v17, v65
    v_add_f32 v18, v18, v66
    v_add_f32 v19, v19, v67
    v_add_f32 v20, v20, v68
    v_add_f32 v21, v21, v69
    v_add_f32 v22, v22, v70
    v_add_f32 v23, v23, v71
    v_cvt_pk_bf16_f32 v40, v16, v17
    v_cvt_pk_bf16_f32 v41, v18, v19
    v_cvt_pk_bf16_f32 v42, v20, v21
    v_cvt_pk_bf16_f32 v43, v22, v23
    s_nop 1
    v_permlane32_swap_b32 v40, v42
    v_permlane32_swap_b32 v41, v43
    s_nop 1
    buffer_store_dwordx4 v[40:43], v8, s[48:51], s77 offen
    s_or_b32 s65, s2, s56
    s_cmp_lg_u32 s65, 0
    s_cbranch_scc1 L_fin
    v_mov_b32 v6, 16384
    v_mov_b32 v7, s69
    s_mov_b64 exec, 1
    buffer_store_dword v7, v6, s[36:39], 0 offen sc0 sc1
    s_mov_b64 exec, -1
L_fin:
L_exit:
    s_endpgm
L_end:

.section .rodata,"a"
.p2align 6
.amdhsa_kernel gated_mix__linear_kernel_hedgehog__linear_kernel_hedgehog__prompt_kernel
  .amdhsa_next_free_vgpr 256
  .amdhsa_next_free_sgpr 102
  .amdhsa_accum_offset 256
  .amdhsa_group_segment_fixed_size 0
  .amdhsa_kernarg_size 96
  .amdhsa_user_sgpr_count 2
  .amdhsa_user_sgpr_kernarg_segment_ptr 1
  .amdhsa_system_sgpr_workgroup_id_x 1
.end_amdhsa_kernel
```
